```python
import torch

def _softmax(x, axis=-1):
    return torch.softmax(x, dim=axis)
def _gelu(x):
    return torch.nn.functional.gelu(x, approximate="tanh")
def _silu(x):
    return torch.nn.functional.silu(x)
def _sigmoid(x):
    return torch.sigmoid(x)
def _layernorm(x, axis=-1, eps=1e-5):
    m = x.mean(dim=axis, keepdim=True)
    v = x.var(dim=axis, keepdim=True, unbiased=False)
    return (x - m) / torch.sqrt(v + eps)
def _scatter_add(tgt, idx, src, axis=0):
    return tgt.clone().index_add_(axis, idx, src)
def _segment_sum(src, seg, n):
    out = torch.zeros((n,) + src.shape[1:], dtype=src.dtype)
    return out.index_add_(0, seg, src)
def _pad(x, pw):
    flat = tuple(v for pair in reversed(pw) for v in pair)
    return torch.nn.functional.pad(x, flat)

kernel_name = 'gather_scatter__edge_featured_mpnn_egc__graph'

def setup_inputs():

    _w = (lambda a: (lambda t: t.to(torch.bfloat16) if t.is_floating_point() else t)(torch.as_tensor(a)))
    N, deg, D, De = 25000, 16, 128, max(4, 1)
    E = N * deg
    return {
        "x": _w((lambda *s: torch.randn(*s, dtype=torch.bfloat16) * 0.1)(N, D)),
        "e_attr": _w((lambda *s: torch.randn(*s, dtype=torch.bfloat16) * 0.1)(E, De)),
        "src": _w((lambda lo, hi, *s: torch.randint(lo, hi, s))(0, N, E).to(torch.int64)),
        "dst": _w((lambda lo, hi, *s: torch.randint(lo, hi, s))(0, N, E).to(torch.int64)),
        "u_w": _w((lambda *s: torch.randn(*s, dtype=torch.bfloat16) * 0.05)(D, D)),
        "v_w": _w((lambda *s: torch.randn(*s, dtype=torch.bfloat16) * 0.05)(D, D)),
        "g_w": _w((lambda *s: torch.randn(*s, dtype=torch.bfloat16) * 0.1)(2 * D + De, D)),
    }

def reference(x, e_attr, src, dst, u_w, v_w, g_w):
    N, D = x.shape
    g_in = torch.concatenate([x[dst], x[src], e_attr], axis=-1)
    eta = _sigmoid(g_in @ g_w)
    hv = x @ v_w
    msg = eta * hv[src]
    agg = _segment_sum(msg, dst, N)
    return _silu(x @ u_w + agg)
```

```asm
; @launch grid=(256,1,1) block=(1024,1,1) lds=162688
.amdgcn_target "amdgcn-amd-amdhsa--gfx950"
.text
.globl gather_scatter__edge_featured_mpnn_egc__graph_kernel
.p2align 8
.type gather_scatter__edge_featured_mpnn_egc__graph_kernel,@function
gather_scatter__edge_featured_mpnn_egc__graph_kernel:
    s_cmp_ge_u32 s2, 256
    s_cbranch_scc1 K_end
    s_load_dwordx16 s[48:63], s[0:1], 0
    s_load_dwordx4 s[64:67], s[0:1], 64
    s_memrealtime s[100:101]
    v_lshrrev_b32 v2, 6, v0
    v_and_b32 v1, 63, v0
    v_readfirstlane_b32 s68, v2
    s_lshr_b32 s69, s2, 3
    s_and_b32 s88, s2, 3
    s_lshl_b32 s88, s88, 5
    s_or_b32 s69, s69, s88
    s_lshr_b32 s70, s2, 1
    s_and_b32 s70, s70, 2
    s_and_b32 s88, s68, 1
    s_or_b32 s70, s70, s88
    s_lshr_b32 s3, s68, 1
    s_mul_i32 s88, s2, 6400
    v_lshl_add_u32 v3, v0, 4, s88
    v_lshlrev_b32 v4, 1, v3
    s_mul_i32 s89, s70, 3203072
    s_waitcnt lgkmcnt(0)
    s_or_b32 s88, s2, s68
    s_cbranch_scc1 K_notag
    s_mov_b32 s8, s64
    s_mov_b32 s9, s65
    s_mov_b32 s10, 256
    s_mov_b32 s11, 0x00020000
    s_or_b32 s88, s100, 1
    v_mov_b32 v13, s88
    v_mov_b32 v10, 0
    s_mov_b64 exec, 1
    buffer_store_dword v13, v10, s[8:11], 0 offen sc1
    s_mov_b64 exec, -1
K_notag:
    s_mov_b32 s16, s54
    s_mov_b32 s17, s55
    s_mov_b32 s18, 1600000
    s_mov_b32 s19, 0x00020000
    s_mov_b32 s12, s52
    s_mov_b32 s13, s53
    s_mov_b32 s14, 1600000
    s_mov_b32 s15, 0x00020000
    s_mov_b32 s8, s50
    s_mov_b32 s9, s51
    s_mov_b32 s10, 3200000
    s_mov_b32 s11, 0x00020000
    s_cmp_ge_u32 s68, 7
    s_cbranch_scc1 K_noedge
    buffer_load_dwordx4 v[72:75], v3, s[16:19], 0 offen
    buffer_load_dwordx4 v[76:79], v3, s[12:15], 0 offen
    buffer_load_dwordx4 v[80:83], v4, s[8:11], 0 offen
    buffer_load_dwordx4 v[84:87], v4, s[8:11], 0 offen offset:16
K_noedge:
    s_lshl_b32 s88, s69, 3
    s_add_u32 s88, s88, s3
    s_mul_i32 s88, s88, 3125
    s_lshr_b32 s72, s88, 7
    s_add_u32 s88, s88, 3125
    s_lshr_b32 s73, s88, 7
    s_cmp_eq_u32 s73, 25000
    s_cselect_b32 s71, 1, 0
    s_sub_u32 s73, s73, s72
    s_add_u32 s71, s71, s73
    s_mov_b32 s86, 0
    s_mov_b32 s87, -1
    s_mov_b32 s4, s48
    s_mov_b32 s5, s49
    s_mov_b32 s6, 6400000
    s_mov_b32 s7, 0x00020000
    s_mov_b32 s24, s62
    s_mov_b32 s25, s63
    s_mov_b32 s26, 6400000
    s_mov_b32 s27, 0x00020000
    s_mov_b32 s44, s60
    s_mov_b32 s45, s61
    s_mov_b32 s46, 66560
    s_mov_b32 s47, 0x00020000
    s_add_u32 s90, s66, s89
    s_addc_u32 s91, s67, 0
    s_mov_b32 s28, s90
    s_mov_b32 s29, s91
    s_mov_b32 s30, 3200128
    s_mov_b32 s31, 0x00020000
    s_sub_u32 s90, s90, 0x4b000000
    s_subb_u32 s91, s91, 0
    s_mov_b32 s32, s90
    s_mov_b32 s33, s91
    s_mov_b32 s34, 1261491328
    s_mov_b32 s35, 0x00020000
    s_add_u32 s90, s66, 0x1000000
    s_addc_u32 s91, s67, 0
    s_mov_b32 s36, s90
    s_mov_b32 s37, s91
    s_mov_b32 s38, 4800000
    s_mov_b32 s39, 0x00020000
    s_add_u32 s90, s66, 0x1800000
    s_addc_u32 s91, s67, 0
    s_mov_b32 s40, s90
    s_mov_b32 s41, s91
    s_mov_b32 s42, 557056
    s_mov_b32 s43, 0x00020000
    s_mov_b32 s74, 0xbfb8aa3b
    s_mov_b32 s75, 0x7f7f0000
    s_mov_b32 s76, 0x07060100
    s_mov_b32 s77, 0x07060302
    s_mov_b32 s78, 10995117
    s_mov_b32 s79, 127
    s_mov_b32 s80, 0x260000
    s_mov_b32 s81, 0x100000
    s_mov_b32 s82, 0x080000
    s_mov_b32 s83, 0x38000000
    s_mov_b32 s84, 62848
    s_mov_b32 s85, 22140
    v_mov_b32 v2, 1
    v_mov_b32 v10, 0
    s_sub_u32 s88, s68, 11
    s_cmp_ge_u32 s88, 4
    s_cbranch_scc1 K_f_nowpf
    s_lshl_b32 s95, s88, 10
    s_lshr_b32 s90, s2, 3
    s_lshr_b32 s91, s90, 3
    s_cmp_eq_u32 s91, 2
    s_cselect_b64 s[20:21], s[58:59], s[56:57]
    s_mov_b32 s22, 32768
    s_cmp_lt_u32 s91, 2
    s_cselect_b64 s[20:21], s[60:61], s[20:21]
    s_cselect_b32 s22, 65536, s22
    s_cselect_b32 s88, 15, 7
    s_mov_b32 s23, 0x00020000
    s_and_b32 s90, s90, s88
    s_lshl_b32 s90, s90, 12
    s_lshr_b32 s89, s70, 1
    s_lshl_b32 s89, s89, 7
    s_add_u32 s90, s90, s89
    s_add_u32 s90, s90, s95
    v_lshl_add_u32 v6, v1, 8, s90
    s_mov_b64 exec, 15
    buffer_load_dword v104, v6, s[20:23], 0 offen
    s_mov_b64 exec, -1
K_f_nowpf:
    s_cmp_lg_u32 s68, 7
    s_cbranch_scc1 K_f_noinit
    v_lshlrev_b32 v7, 2, v1
    v_lshrrev_b32 v8, 1, v1
    v_mul_u32_u24 v8, 2544, v8
    v_and_b32 v9, 1, v1
    v_mul_u32_u24 v9, 1080, v9
    v_add_u32 v8, v8, v9
    v_add_u32 v8, 1792, v8
    v_cmp_gt_u32 vcc, 16, v1
    ds_write_b32 v7, v10 offset:0
    ds_write_b32 v7, v10 offset:256
    ds_write_b32 v7, v10 offset:512
    ds_write_b32 v7, v10 offset:768
    v_cndmask_b32 v8, 0, v8, vcc
    ds_write_b32 v7, v8 offset:1536
    s_getpc_b64 s[90:91]
K_pc:
    v_lshlrev_b32 v9, 7, v1
    global_load_dword v104, v9, s[90:91]
    v_add_u32 v9, 8192, v9
    v_cmp_gt_u32 vcc, K_code_end - K_pc - 4, v9
    s_mov_b64 exec, vcc
    global_load_dword v105, v9, s[90:91]
    s_mov_b64 exec, -1
    s_waitcnt lgkmcnt(0)
K_f_noinit:
    s_cmp_lg_u32 s68, 15
    s_cbranch_scc1 K_tag_done
    s_mov_b32 s8, s64
    s_mov_b32 s9, s65
    s_mov_b32 s10, 256
    s_mov_b32 s11, 0x00020000
    buffer_load_dword v51, v10, s[8:11], 0 offen sc1
K_tag_done:
    s_barrier
    s_cmp_eq_u32 s68, 15
    s_cbranch_scc1 K_f_w15
    s_cmp_ge_u32 s68, 7
    s_cbranch_scc1 K_f_loader
    s_setprio 0
    s_cmp_lt_u32 s2, 250
    s_cselect_b32 s88, 400, 0
    v_cmp_gt_u32 vcc, s88, v0
    s_mov_b64 s[96:97], vcc
    s_waitcnt vmcnt(3)
    v_lshl_or_b32 v88, v72, 7, s79
    v_mul_hi_u32 v88, v88, s78
    v_lshrrev_b32 v92, 4, v88
    v_and_b32 v92, 0x1fc, v92
    v_lshl_or_b32 v89, v73, 7, s79
    v_mul_hi_u32 v89, v89, s78
    v_lshrrev_b32 v93, 4, v89
    v_and_b32 v93, 0x1fc, v93
    v_lshl_or_b32 v90, v74, 7, s79
    v_mul_hi_u32 v90, v90, s78
    v_lshrrev_b32 v94, 4, v90
    v_and_b32 v94, 0x1fc, v94
    v_lshl_or_b32 v91, v75, 7, s79
    v_mul_hi_u32 v91, v91, s78
    v_lshrrev_b32 v95, 4, v91
    v_and_b32 v95, 0x1fc, v95
    s_mov_b64 exec, s[96:97]
    ds_add_rtn_u32 v96, v92, v2 offset:0
    ds_add_rtn_u32 v97, v93, v2 offset:0
    ds_add_rtn_u32 v98, v94, v2 offset:0
    ds_add_rtn_u32 v99, v95, v2 offset:0
    s_mov_b64 exec, 1
    ds_add_u32 v10, v2 offset:1676
    s_mov_b64 exec, -1
    v_lshrrev_b32 v100, 3, v88
    v_mul_u32_u24 v101, 3125, v100
    v_lshrrev_b32 v101, 7, v101
    v_sub_u32 v101, v72, v101
    v_lshlrev_b32 v88, 27, v100
    v_and_b32 v88, s83, v88
    v_lshlrev_b32 v102, 17, v101
    v_and_or_b32 v88, v102, s80, v88
    v_lshlrev_b32 v102, 18, v101
    v_and_or_b32 v88, v102, s81, v88
    v_lshlrev_b32 v102, 16, v101
    v_and_or_b32 v88, v102, s82, v88
    v_lshrrev_b32 v100, 3, v89
    v_mul_u32_u24 v101, 3125, v100
    v_lshrrev_b32 v101, 7, v101
    v_sub_u32 v101, v73, v101
    v_lshlrev_b32 v89, 27, v100
    v_and_b32 v89, s83, v89
    v_lshlrev_b32 v102, 17, v101
    v_and_or_b32 v89, v102, s80, v89
    v_lshlrev_b32 v102, 18, v101
    v_and_or_b32 v89, v102, s81, v89
    v_lshlrev_b32 v102, 16, v101
    v_and_or_b32 v89, v102, s82, v89
    v_lshrrev_b32 v100, 3, v90
    v_mul_u32_u24 v101, 3125, v100
    v_lshrrev_b32 v101, 7, v101
    v_sub_u32 v101, v74, v101
    v_lshlrev_b32 v90, 27, v100
    v_and_b32 v90, s83, v90
    v_lshlrev_b32 v102, 17, v101
    v_and_or_b32 v90, v102, s80, v90
    v_lshlrev_b32 v102, 18, v101
    v_and_or_b32 v90, v102, s81, v90
    v_lshlrev_b32 v102, 16, v101
    v_and_or_b32 v90, v102, s82, v90
    v_lshrrev_b32 v100, 3, v91
    v_mul_u32_u24 v101, 3125, v100
    v_lshrrev_b32 v101, 7, v101
    v_sub_u32 v101, v75, v101
    v_lshlrev_b32 v91, 27, v100
    v_and_b32 v91, s83, v91
    v_lshlrev_b32 v102, 17, v101
    v_and_or_b32 v91, v102, s80, v91
    v_lshlrev_b32 v102, 18, v101
    v_and_or_b32 v91, v102, s81, v91
    v_lshlrev_b32 v102, 16, v101
    v_and_or_b32 v91, v102, s82, v91
    s_lshl_b32 s89, s68, 10
    v_lshl_add_u32 v3, v1, 4, s89
    v_add_u32 v7, 62848, v3
    s_mul_i32 s89, s2, 19200
    v_add_u32 v3, s89, v3
K_f_s2:
    ds_read_b32 v11, v10 offset:1676
    s_waitcnt lgkmcnt(0)
    v_readfirstlane_b32 s88, v11
    s_cmp_lt_u32 s88, 7
    s_cbranch_scc1 K_f_s2
    v_lshlrev_b32 v100, 3, v1
    ds_read_b64 v[104:105], v100 offset:0
    s_waitcnt lgkmcnt(0)
    v_add_u32 v101, v104, v105
    v_mov_b32 v102, v101
    s_nop 1
    v_add_u32_dpp v102, v102, v102 row_shr:1 row_mask:0xf bank_mask:0xf bound_ctrl:0
    s_nop 1
    v_add_u32_dpp v102, v102, v102 row_shr:2 row_mask:0xf bank_mask:0xf bound_ctrl:0
    s_nop 1
    v_add_u32_dpp v102, v102, v102 row_shr:4 row_mask:0xf bank_mask:0xf bound_ctrl:0
    s_nop 1
    v_add_u32_dpp v102, v102, v102 row_shr:8 row_mask:0xf bank_mask:0xf bound_ctrl:0
    s_nop 1
    v_add_u32_dpp v102, v102, v102 row_bcast:15 row_mask:0xa bank_mask:0xf
    s_nop 1
    v_add_u32_dpp v102, v102, v102 row_bcast:31 row_mask:0xc bank_mask:0xf
    v_sub_u32 v106, v102, v101
    v_add_u32 v107, v106, v104
    ds_write_b64 v100, v[106:107] offset:1024
    ds_read_b32 v72, v92 offset:1024
    ds_read_b32 v73, v93 offset:1024
    ds_read_b32 v74, v94 offset:1024
    ds_read_b32 v75, v95 offset:1024
    s_mov_b32 s90, 20268
    s_mov_b32 s91, 0x04000000
    s_waitcnt vmcnt(0)
    v_add_lshl_u32 v101, v76, s90, 11
    v_or_b32 v88, v88, v76
    v_and_or_b32 v88, v101, s91, v88
    v_add3_u32 v76, v80, v81, v88
    v_add_lshl_u32 v101, v77, s90, 11
    v_or_b32 v89, v89, v77
    v_and_or_b32 v89, v101, s91, v89
    v_add3_u32 v77, v82, v83, v89
    v_add_lshl_u32 v101, v78, s90, 11
    v_or_b32 v90, v90, v78
    v_and_or_b32 v90, v101, s91, v90
    v_add3_u32 v78, v84, v85, v90
    v_add_lshl_u32 v101, v79, s90, 11
    v_or_b32 v91, v91, v79
    v_and_or_b32 v91, v101, s91, v91
    v_add3_u32 v79, v86, v87, v91
    s_waitcnt lgkmcnt(0)
    v_add_u32 v96, v96, v72
    v_mad_u32_u24 v96, v96, 12, s84
    v_add_u32 v97, v97, v73
    v_mad_u32_u24 v97, v97, 12, s84
    v_add_u32 v98, v98, v74
    v_mad_u32_u24 v98, v98, 12, s84
    v_add_u32 v99, v99, v75
    v_mad_u32_u24 v99, v99, 12, s84
    s_mov_b64 exec, s[96:97]
    ds_write2_b32 v96, v80, v81 offset0:0 offset1:1
    ds_write_b32 v96, v88 offset:8
    ds_add_u32 v92, v76 offset:512
    ds_write2_b32 v97, v82, v83 offset0:0 offset1:1
    ds_write_b32 v97, v89 offset:8
    ds_add_u32 v93, v77 offset:512
    ds_write2_b32 v98, v84, v85 offset0:0 offset1:1
    ds_write_b32 v98, v90 offset:8
    ds_add_u32 v94, v78 offset:512
    ds_write2_b32 v99, v86, v87 offset0:0 offset1:1
    ds_write_b32 v99, v91 offset:8
    ds_add_u32 v95, v79 offset:512
    s_mov_b64 exec, 1
    ds_add_u32 v10, v2 offset:1680
    s_mov_b64 exec, -1
K_f_s3:
    ds_read_b32 v11, v10 offset:1680
    s_waitcnt lgkmcnt(0)
    v_readfirstlane_b32 s88, v11
    s_cmp_lt_u32 s88, 7
    s_cbranch_scc1 K_f_s3
    ds_read_b128 v[104:107], v7 offset:0
    ds_read_b128 v[108:111], v7 offset:7168
    ds_read_b128 v[112:115], v7 offset:14336
    s_mov_b64 exec, 1
    ds_add_u32 v10, v2 offset:1680
    s_mov_b64 exec, -1
    v_add_u32 v4, 7168, v3
    v_add_u32 v5, 14336, v3
    s_waitcnt lgkmcnt(3)
    buffer_store_dwordx4 v[104:107], v3, s[36:39], 0 offen sc1
    s_waitcnt lgkmcnt(2)
    buffer_store_dwordx4 v[108:111], v4, s[36:39], 0 offen sc1
    s_cmp_gt_u32 s68, 4
    s_cbranch_scc1 K_f_x0
    s_cmp_eq_u32 s68, 4
    s_cselect_b32 exec_hi, 0xffff, -1
    s_waitcnt lgkmcnt(1)
    buffer_store_dwordx4 v[112:115], v5, s[36:39], 0 offen sc1
    s_mov_b64 exec, -1
K_f_x0:
    s_setprio 0
    s_branch K_f_done
K_f_loader:
    s_cmp_ge_u32 s68, 11
    s_cbranch_scc1 K_f_w
    v_lshrrev_b32 v6, 4, v1
    v_xor_b32 v7, v6, v1
    v_and_b32 v7, 15, v7
    v_lshlrev_b32 v72, 8, v6
    v_lshl_add_u32 v72, v7, 4, v72
    v_xor_b32 v73, 64, v72
    v_xor_b32 v74, 128, v72
    v_xor_b32 v75, 192, v72
    s_sub_u32 s91, s68, 3
    s_mul_i32 s90, s91, 6656
    s_lshl_b32 s89, s69, 3
    s_add_u32 s89, s89, s91
    s_mul_i32 s89, s89, 3125
    s_lshr_b32 s89, s89, 7
    s_lshl_b32 s89, s89, 8
    s_lshl_b32 s88, s91, 2
    v_mov_b32 v12, s88
    s_add_u32 m0, s90, 1792
    v_add_u32 v6, s89, v72
    s_add_u32 s89, s89, 1024
    buffer_load_dwordx4 v6, s[4:7], 0 offen lds
    s_add_u32 m0, s90, 2816
    v_add_u32 v6, s89, v73
    s_add_u32 s89, s89, 1024
    buffer_load_dwordx4 v6, s[4:7], 0 offen lds
    s_add_u32 m0, s90, 3840
    v_add_u32 v6, s89, v74
    s_add_u32 s89, s89, 1024
    buffer_load_dwordx4 v6, s[4:7], 0 offen lds
    s_add_u32 m0, s90, 4864
    v_add_u32 v6, s89, v75
    s_add_u32 s89, s89, 1024
    buffer_load_dwordx4 v6, s[4:7], 0 offen lds
    s_add_u32 m0, s90, 5888
    v_add_u32 v6, s89, v72
    s_add_u32 s89, s89, 1024
    buffer_load_dwordx4 v6, s[4:7], 0 offen lds
    s_add_u32 m0, s90, 6912
    v_add_u32 v6, s89, v73
    s_add_u32 s89, s89, 1024
    buffer_load_dwordx4 v6, s[4:7], 0 offen lds
    s_add_u32 m0, s90, 7936
    v_add_u32 v6, s89, v74
    s_not_b64 exec, s[86:87]
    buffer_load_dwordx4 v6, s[4:7], 0 offen lds
    s_mov_b64 exec, -1
    s_sub_u32 s91, s68, 7
    s_mul_i32 s90, s91, 6656
    s_lshl_b32 s89, s69, 3
    s_add_u32 s89, s89, s91
    s_mul_i32 s89, s89, 3125
    s_lshr_b32 s89, s89, 7
    s_lshl_b32 s89, s89, 8
    s_lshl_b32 s88, s91, 2
    v_mov_b32 v13, s88
    s_add_u32 m0, s90, 1792
    v_add_u32 v6, s89, v72
    s_add_u32 s89, s89, 1024
    buffer_load_dwordx4 v6, s[4:7], 0 offen lds
    s_add_u32 m0, s90, 2816
    v_add_u32 v6, s89, v73
    s_add_u32 s89, s89, 1024
    buffer_load_dwordx4 v6, s[4:7], 0 offen lds
    s_add_u32 m0, s90, 3840
    v_add_u32 v6, s89, v74
    s_add_u32 s89, s89, 1024
    buffer_load_dwordx4 v6, s[4:7], 0 offen lds
    s_add_u32 m0, s90, 4864
    v_add_u32 v6, s89, v75
    s_add_u32 s89, s89, 1024
    buffer_load_dwordx4 v6, s[4:7], 0 offen lds
    s_add_u32 m0, s90, 5888
    v_add_u32 v6, s89, v72
    s_add_u32 s89, s89, 1024
    buffer_load_dwordx4 v6, s[4:7], 0 offen lds
    s_add_u32 m0, s90, 6912
    v_add_u32 v6, s89, v73
    s_add_u32 s89, s89, 1024
    buffer_load_dwordx4 v6, s[4:7], 0 offen lds
    s_add_u32 m0, s90, 7936
    v_add_u32 v6, s89, v74
    s_not_b64 exec, s[86:87]
    buffer_load_dwordx4 v6, s[4:7], 0 offen lds
    s_mov_b64 exec, -1
    s_waitcnt vmcnt(7)
    ds_write_b32 v12, v2 offset:1728
    s_waitcnt vmcnt(0)
    ds_write_b32 v13, v2 offset:1728
    s_branch K_f_done
K_f_w:
    s_waitcnt vmcnt(0)
    s_setprio 3
    s_sub_u32 s90, s68, 11
    s_and_b32 s91, s90, 6
    s_lshr_b32 s91, 0xc9, s91
    s_and_b32 s91, s91, 3
    s_cmp_eq_u32 s91, 2
    s_cselect_b64 s[20:21], s[58:59], s[56:57]
    s_mov_b32 s22, 32768
    s_cmp_lt_u32 s91, 2
    s_cselect_b64 s[20:21], s[60:61], s[20:21]
    s_cselect_b32 s22, 65536, s22
    s_mov_b32 s23, 0x00020000
    s_cmp_eq_u32 s91, 1
    s_cselect_b32 s88, 32768, 0
    s_and_b32 s90, s90, 1
    s_lshl_b32 s89, s90, 14
    s_add_u32 s88, s88, s89
    s_lshr_b32 s89, s70, 1
    s_lshl_b32 s89, s89, 7
    s_add_u32 s88, s88, s89
    v_lshrrev_b32 v4, 3, v1
    v_lshl_add_u32 v4, v4, 8, s88
    v_bfe_u32 v6, v1, 4, 1
    v_lshlrev_b32 v6, 2, v6
    v_xor_b32 v6, v6, v1
    v_and_b32 v6, 7, v6
    v_lshl_add_u32 v4, v6, 4, v4
    s_lshl_b32 s88, s91, 14
    s_lshl_b32 s90, s90, 13
    s_add_u32 s88, s88, s90
    s_add_u32 m0, s88, 95616
    s_mov_b32 s89, 0
    buffer_load_dwordx4 v4, s[20:23], s89 offen lds
    s_add_u32 m0, s88, 96640
    s_mov_b32 s89, 2048
    buffer_load_dwordx4 v4, s[20:23], s89 offen lds
    s_add_u32 m0, s88, 97664
    s_mov_b32 s89, 4096
    buffer_load_dwordx4 v4, s[20:23], s89 offen lds
    s_add_u32 m0, s88, 98688
    s_mov_b32 s89, 6144
    buffer_load_dwordx4 v4, s[20:23], s89 offen lds
    s_add_u32 m0, s88, 99712
    s_mov_b32 s89, 8192
    buffer_load_dwordx4 v4, s[20:23], s89 offen lds
    s_add_u32 m0, s88, 100736
    s_mov_b32 s89, 10240
    buffer_load_dwordx4 v4, s[20:23], s89 offen lds
    s_add_u32 m0, s88, 101760
    s_mov_b32 s89, 12288
    buffer_load_dwordx4 v4, s[20:23], s89 offen lds
    s_add_u32 m0, s88, 102784
    s_mov_b32 s89, 14336
    buffer_load_dwordx4 v4, s[20:23], s89 offen lds
    s_setprio 0
    s_waitcnt vmcnt(0)
    s_mov_b64 exec, 1
    ds_add_u32 v10, v2 offset:1684
    s_mov_b64 exec, -1
    s_sub_u32 s90, s68, 7
    s_and_b32 s91, s90, 6
    s_lshr_b32 s91, 0xc9, s91
    s_and_b32 s91, s91, 3
    s_cmp_eq_u32 s91, 2
    s_cselect_b64 s[20:21], s[58:59], s[56:57]
    s_mov_b32 s22, 32768
    s_cmp_lt_u32 s91, 2
    s_cselect_b64 s[20:21], s[60:61], s[20:21]
    s_cselect_b32 s22, 65536, s22
    s_mov_b32 s23, 0x00020000
    s_cmp_eq_u32 s91, 1
    s_cselect_b32 s88, 32768, 0
    s_and_b32 s90, s90, 1
    s_lshl_b32 s89, s90, 14
    s_add_u32 s88, s88, s89
    s_lshr_b32 s89, s70, 1
    s_lshl_b32 s89, s89, 7
    s_add_u32 s88, s88, s89
    v_lshrrev_b32 v4, 3, v1
    v_lshl_add_u32 v4, v4, 8, s88
    v_bfe_u32 v6, v1, 4, 1
    v_lshlrev_b32 v6, 2, v6
    v_xor_b32 v6, v6, v1
    v_and_b32 v6, 7, v6
    v_lshl_add_u32 v4, v6, 4, v4
    s_lshl_b32 s88, s91, 14
    s_lshl_b32 s90, s90, 13
    s_add_u32 s88, s88, s90
    s_add_u32 m0, s88, 95616
    s_mov_b32 s89, 0
    buffer_load_dwordx4 v4, s[20:23], s89 offen lds
    s_add_u32 m0, s88, 96640
    s_mov_b32 s89, 2048
    buffer_load_dwordx4 v4, s[20:23], s89 offen lds
    s_add_u32 m0, s88, 97664
    s_mov_b32 s89, 4096
    buffer_load_dwordx4 v4, s[20:23], s89 offen lds
    s_add_u32 m0, s88, 98688
    s_mov_b32 s89, 6144
    buffer_load_dwordx4 v4, s[20:23], s89 offen lds
    s_add_u32 m0, s88, 99712
    s_mov_b32 s89, 8192
    buffer_load_dwordx4 v4, s[20:23], s89 offen lds
    s_add_u32 m0, s88, 100736
    s_mov_b32 s89, 10240
    buffer_load_dwordx4 v4, s[20:23], s89 offen lds
    s_add_u32 m0, s88, 101760
    s_mov_b32 s89, 12288
    buffer_load_dwordx4 v4, s[20:23], s89 offen lds
    s_add_u32 m0, s88, 102784
    s_mov_b32 s89, 14336
    buffer_load_dwordx4 v4, s[20:23], s89 offen lds
    s_cmp_lg_u32 s68, 11
    s_cbranch_scc1 K_nocf
    v_and_b32 v6, 7, v1
    v_lshrrev_b32 v4, 3, v1
    v_lshlrev_b32 v4, 8, v4
    v_lshl_add_u32 v4, v6, 4, v4
    s_lshr_b32 s89, s70, 1
    s_lshl_b32 s89, s89, 7
    s_add_u32 s89, s89, 65536
    s_mov_b32 m0, 162176
    s_not_b64 exec, s[86:87]
    buffer_load_dwordx4 v4, s[44:47], s89 offen lds
    s_mov_b64 exec, -1
K_nocf:
    s_branch K_f_done
K_f_w15:
    s_setprio 3
    s_lshl_b32 s88, s2, 11
    v_lshl_add_u32 v4, v1, 5, s88
    s_mov_b32 s95, 1000000
    s_sleep 3
    buffer_load_dword v55, v10, s[8:11], 0 offen sc1
    s_sleep 3
    buffer_load_dword v123, v10, s[8:11], 0 offen sc1
    s_sleep 3
    buffer_load_dword v127, v10, s[8:11], 0 offen sc1
    s_waitcnt vmcnt(3)
    v_readfirstlane_b32 s98, v51
    s_cmp_lg_u32 s98, 0
    s_cbranch_scc1 K_tag_ok
    s_waitcnt vmcnt(2)
    v_readfirstlane_b32 s98, v55
    s_cmp_lg_u32 s98, 0
    s_cbranch_scc1 K_tag_ok
    s_waitcnt vmcnt(1)
    v_readfirstlane_b32 s98, v123
    s_cmp_lg_u32 s98, 0
    s_cbranch_scc1 K_tag_ok
    s_waitcnt vmcnt(0)
    v_readfirstlane_b32 s98, v127
    s_cmp_lg_u32 s98, 0
    s_cbranch_scc1 K_tag_ok
K_tag_loop:
    buffer_load_dword v13, v10, s[8:11], 0 offen sc1
    s_waitcnt vmcnt(0)
    v_readfirstlane_b32 s98, v13
    s_cmp_lg_u32 s98, 0
    s_cbranch_scc1 K_tag_ok
    s_sub_u32 s95, s95, 1
    s_cbranch_scc0 K_tag_loop
    s_mov_b32 s98, 1
K_tag_ok:
    v_mov_b32 v13, s98
    ds_write_b32 v10, v13 offset:1672
    s_mul_i32 s99, s98, 0x9e3779b1
    s_and_b32 s99, s99, 0xf800f800
K_f_s2b:
    ds_read_b32 v11, v10 offset:1676
    s_waitcnt lgkmcnt(0)
    v_readfirstlane_b32 s88, v11
    s_cmp_lt_u32 s88, 7
    s_cbranch_scc1 K_f_s2b
    v_lshlrev_b32 v100, 3, v1
    ds_read_b64 v[104:105], v100 offset:0
    s_waitcnt lgkmcnt(0)
    v_add_u32 v101, v104, v105
    v_mov_b32 v102, v101
    s_nop 1
    v_add_u32_dpp v102, v102, v102 row_shr:1 row_mask:0xf bank_mask:0xf bound_ctrl:0
    s_nop 1
    v_add_u32_dpp v102, v102, v102 row_shr:2 row_mask:0xf bank_mask:0xf bound_ctrl:0
    s_nop 1
    v_add_u32_dpp v102, v102, v102 row_shr:4 row_mask:0xf bank_mask:0xf bound_ctrl:0
    s_nop 1
    v_add_u32_dpp v102, v102, v102 row_shr:8 row_mask:0xf bank_mask:0xf bound_ctrl:0
    s_nop 1
    v_add_u32_dpp v102, v102, v102 row_bcast:15 row_mask:0xa bank_mask:0xf
    s_nop 1
    v_add_u32_dpp v102, v102, v102 row_bcast:31 row_mask:0xc bank_mask:0xf
    v_sub_u32 v106, v102, v101
    v_add_u32 v107, v106, v104
    v_lshl_or_b32 v108, v104, 16, v106
    v_or_b32 v108, s99, v108
    v_mov_b32 v109, v13
    v_lshl_or_b32 v112, v105, 16, v107
    v_or_b32 v112, s99, v112
    v_mov_b32 v113, v13
K_f_s3b:
    ds_read_b32 v11, v10 offset:1680
    s_waitcnt lgkmcnt(0)
    v_readfirstlane_b32 s88, v11
    s_cmp_lt_u32 s88, 7
    s_cbranch_scc1 K_f_s3b
    ds_read_b32 v110, v100 offset:512
    ds_read_b32 v114, v100 offset:516
    s_waitcnt lgkmcnt(0)
    buffer_store_dwordx4 v[108:111], v4, s[40:43], 0 offen sc1
    buffer_store_dwordx4 v[112:115], v4, s[40:43], 0 offen offset:16 sc1
    s_setprio 0
K_f_done:
    s_and_b32 s89, s68, 1
    v_lshrrev_b32 v6, 5, v1
    v_lshlrev_b32 v4, 10, v6
    v_bfe_u32 v6, v1, 2, 2
    v_lshl_add_u32 v4, v6, 7, v4
    v_bfe_u32 v6, v1, 3, 1
    v_xor_b32 v6, s89, v6
    v_lshl_add_u32 v4, v6, 6, v4
    v_and_b32 v6, 1, v1
    v_lshl_add_u32 v4, v6, 5, v4
    v_and_b32 v6, 16, v1
    v_add_u32 v4, v6, v4
    v_and_b32 v6, 2, v1
    v_lshl_add_u32 v4, v6, 2, v4
    v_add_u32 v4, 95616, v4
    s_lshl_b32 s88, s3, 2
    v_mov_b32 v12, s88
K_xw:
    ds_read_b32 v15, v10 offset:1684
    ds_read_b32 v13, v12 offset:1728
    s_waitcnt lgkmcnt(0)
    v_add_u32 v7, v15, v13
    s_nop 0
    v_readfirstlane_b32 s88, v7
    s_cmp_eq_u32 s88, 5
    s_cbranch_scc1 K_xok
    s_sleep 1
    s_branch K_xw
K_xok:
    s_setprio 2
    s_cmp_lg_u32 s68, 15
    s_cbranch_scc1 K_xp
    s_setprio 3
K_xp:
    s_lshl_b32 s88, s69, 4
    v_lshl_add_u32 v8, v1, 13, s88
    v_add_u32 v9, 4096, v8
    s_cmp_lg_u32 s68, 15
    s_cbranch_scc1 K_poa
    s_mov_b64 s[44:45], -1
    s_mov_b32 s95, 1000000
    s_mov_b64 exec, s[44:45]
    buffer_load_dwordx3 v[48:50], v8, s[40:43], 0 offen offset:0 sc1
    buffer_load_dwordx3 v[52:54], v8, s[40:43], 0 offen offset:2048 sc1
    buffer_load_dwordx3 v[120:122], v9, s[40:43], 0 offen offset:0 sc1
    buffer_load_dwordx3 v[124:126], v9, s[40:43], 0 offen offset:2048 sc1
    s_mov_b64 exec, -1
K_poa:
    s_mul_i32 s89, s3, 6656
    s_add_u32 s89, s89, 1792
    v_and_b32 v6, 31, v1
    v_lshrrev_b32 v7, 5, v1
    v_xor_b32 v7, v7, v6
    v_and_b32 v7, 15, v7
    v_lshl_add_u32 v6, v6, 8, s89
    v_lshl_add_u32 v6, v7, 4, v6
    ds_read_b128 v[16:19], v6
    v_xor_b32 v7, 32, v6
    ds_read_b128 v[20:23], v7
    v_xor_b32 v7, 64, v6
    ds_read_b128 v[24:27], v7
    v_xor_b32 v7, 96, v6
    ds_read_b128 v[28:31], v7
    v_xor_b32 v7, 128, v6
    ds_read_b128 v[56:59], v7
    v_xor_b32 v7, 160, v6
    ds_read_b128 v[60:63], v7
    v_xor_b32 v7, 192, v6
    ds_read_b128 v[64:67], v7
    v_xor_b32 v7, 224, v6
    ds_read_b128 v[68:71], v7
    s_mov_b64 exec, 1
    ds_add_u32 v10, v2 offset:1692
    s_mov_b64 exec, -1
    ds_read_b64_tr_b16 v[72:73], v4 offset:16384
    ds_read_b64_tr_b16 v[74:75], v4 offset:16896
    ds_read_b64_tr_b16 v[76:77], v4 offset:32768
    ds_read_b64_tr_b16 v[78:79], v4 offset:33280
    ds_read_b64_tr_b16 v[80:81], v4 offset:18432
    ds_read_b64_tr_b16 v[82:83], v4 offset:18944
    ds_read_b64_tr_b16 v[84:85], v4 offset:34816
    ds_read_b64_tr_b16 v[86:87], v4 offset:35328
    ds_read_b64_tr_b16 v[88:89], v4 offset:20480
    ds_read_b64_tr_b16 v[90:91], v4 offset:20992
    ds_read_b64_tr_b16 v[92:93], v4 offset:36864
    ds_read_b64_tr_b16 v[94:95], v4 offset:37376
    ds_read_b64_tr_b16 v[96:97], v4 offset:22528
    ds_read_b64_tr_b16 v[98:99], v4 offset:23040
    ds_read_b64_tr_b16 v[100:101], v4 offset:38912
    ds_read_b64_tr_b16 v[102:103], v4 offset:39424
    s_waitcnt lgkmcnt(12)
    v_mfma_f32_32x32x16_bf16 v[104:119], v[16:19], v[72:75], 0
    v_mfma_f32_32x32x16_bf16 v[32:47], v[16:19], v[76:79], 0
    ds_read_b64_tr_b16 v[72:73], v4 offset:24576
    ds_read_b64_tr_b16 v[74:75], v4 offset:25088
    ds_read_b64_tr_b16 v[76:77], v4 offset:40960
    ds_read_b64_tr_b16 v[78:79], v4 offset:41472
    s_waitcnt lgkmcnt(12)
    v_mfma_f32_32x32x16_bf16 v[104:119], v[20:23], v[80:83], v[104:119]
    v_mfma_f32_32x32x16_bf16 v[32:47], v[20:23], v[84:87], v[32:47]
    ds_read_b64_tr_b16 v[80:81], v4 offset:26624
    ds_read_b64_tr_b16 v[82:83], v4 offset:27136
    ds_read_b64_tr_b16 v[84:85], v4 offset:43008
    ds_read_b64_tr_b16 v[86:87], v4 offset:43520
    s_waitcnt lgkmcnt(12)
    v_mfma_f32_32x32x16_bf16 v[104:119], v[24:27], v[88:91], v[104:119]
    v_mfma_f32_32x32x16_bf16 v[32:47], v[24:27], v[92:95], v[32:47]
    ds_read_b64_tr_b16 v[88:89], v4 offset:28672
    ds_read_b64_tr_b16 v[90:91], v4 offset:29184
    ds_read_b64_tr_b16 v[92:93], v4 offset:45056
    ds_read_b64_tr_b16 v[94:95], v4 offset:45568
    s_waitcnt lgkmcnt(12)
    v_mfma_f32_32x32x16_bf16 v[104:119], v[28:31], v[96:99], v[104:119]
    v_mfma_f32_32x32x16_bf16 v[32:47], v[28:31], v[100:103], v[32:47]
    ds_read_b64_tr_b16 v[96:97], v4 offset:30720
    ds_read_b64_tr_b16 v[98:99], v4 offset:31232
    ds_read_b64_tr_b16 v[100:101], v4 offset:47104
    ds_read_b64_tr_b16 v[102:103], v4 offset:47616
    s_waitcnt lgkmcnt(12)
    v_mfma_f32_32x32x16_bf16 v[104:119], v[56:59], v[72:75], v[104:119]
    v_mfma_f32_32x32x16_bf16 v[32:47], v[56:59], v[76:79], v[32:47]
    s_waitcnt lgkmcnt(8)
    v_mfma_f32_32x32x16_bf16 v[104:119], v[60:63], v[80:83], v[104:119]
    v_mfma_f32_32x32x16_bf16 v[32:47], v[60:63], v[84:87], v[32:47]
    s_waitcnt lgkmcnt(4)
    v_mfma_f32_32x32x16_bf16 v[104:119], v[64:67], v[88:91], v[104:119]
    v_mfma_f32_32x32x16_bf16 v[32:47], v[64:67], v[92:95], v[32:47]
    s_waitcnt lgkmcnt(0)
    v_mfma_f32_32x32x16_bf16 v[104:119], v[68:71], v[96:99], v[104:119]
    v_mfma_f32_32x32x16_bf16 v[32:47], v[68:71], v[100:103], v[32:47]
    s_branch K_s3w
K_s3w_nap:
    s_sleep 1
K_s3w:
    ds_read_b32 v11, v10 offset:1680
    s_waitcnt lgkmcnt(0)
    v_readfirstlane_b32 s88, v11
    s_cmp_lt_u32 s88, 14
    s_cbranch_scc1 K_s3w_nap
    s_cmp_lg_u32 s68, 15
    s_cbranch_scc1 K_pob
    s_cmp_eq_u64 s[44:45], 0
    s_cbranch_scc1 K_pob
K_plb:
    s_waitcnt vmcnt(0)
    v_xor_b32 v51, s99, v48
    v_and_b32 v51, 0xf800f800, v51
    v_xor_b32 v7, s98, v49
    v_or3_b32 v6, v51, v7, 0
    v_xor_b32 v55, s99, v52
    v_and_b32 v55, 0xf800f800, v55
    v_xor_b32 v7, s98, v53
    v_or3_b32 v6, v55, v7, v6
    v_xor_b32 v123, s99, v120
    v_and_b32 v123, 0xf800f800, v123
    v_xor_b32 v7, s98, v121
    v_or3_b32 v6, v123, v7, v6
    v_xor_b32 v127, s99, v124
    v_and_b32 v127, 0xf800f800, v127
    v_xor_b32 v7, s98, v125
    v_or3_b32 v6, v127, v7, v6
    v_cmp_ne_u32 s[44:45], 0, v6
    s_sub_u32 s95, s95, 1
    s_cselect_b64 s[44:45], 0, s[44:45]
    s_cmp_lg_u64 s[44:45], 0
    s_cbranch_scc1 K_pab
    v_lshlrev_b32 v7, 5, v1
    v_add_u32 v7, 62848, v7
    v_mov_b32 v6, s98
    ds_write2_b32 v7, v48, v50 offset0:0 offset1:1
    ds_write2_b32 v7, v52, v54 offset0:2 offset1:3
    ds_write2_b32 v7, v120, v122 offset0:4 offset1:5
    ds_write2_b32 v7, v124, v126 offset0:6 offset1:7
    ds_write_b32 v10, v6 offset:1664
    s_branch K_pob
K_pab:
    s_mov_b64 exec, s[44:45]
    buffer_load_dwordx3 v[48:50], v8, s[40:43], 0 offen offset:0 sc1
    buffer_load_dwordx3 v[52:54], v8, s[40:43], 0 offen offset:2048 sc1
    buffer_load_dwordx3 v[120:122], v9, s[40:43], 0 offen offset:0 sc1
    buffer_load_dwordx3 v[124:126], v9, s[40:43], 0 offen offset:2048 sc1
    s_mov_b64 exec, -1
K_pob:
    s_sub_u32 s88, s68, 11
    s_cmp_ge_u32 s88, 4
    s_cbranch_scc1 K_noau
    s_waitcnt vmcnt(0)
    s_mov_b64 exec, 1
    ds_add_u32 v10, v2 offset:1688
    s_mov_b64 exec, -1
K_noau:
    s_lshl_b32 s89, s68, 10
    s_add_u32 s89, s89, 64896
    v_lshrrev_b32 v6, 5, v1
    v_lshl_add_u32 v6, v6, 9, s89
    v_and_b32 v7, 31, v1
    v_lshl_add_u32 v6, v7, 2, v6
    v_lshl_add_u32 v7, v1, 4, s89
    s_lshl_b32 s88, s72, 7
    v_lshl_add_u32 v5, v1, 4, s88
    s_nop 5
    v_rcp_f32 v32, v32
    v_mul_f32 v104, s74, v104
    v_rcp_f32 v33, v33
    v_mul_f32 v105, s74, v105
    v_med3_f32 v32, v32, s75, -s75
    v_med3_f32 v33, v33, s75, -s75
    v_cvt_pk_bf16_f32 v32, v32, v33
    v_perm_b32 v104, v104, v32, s76
    v_perm_b32 v105, v105, v32, s77
    ds_write_b32 v6, v104 offset:0
    ds_write_b32 v6, v105 offset:128
    v_rcp_f32 v34, v34
    v_mul_f32 v106, s74, v106
    v_rcp_f32 v35, v35
    v_mul_f32 v107, s74, v107
    v_med3_f32 v34, v34, s75, -s75
    v_med3_f32 v35, v35, s75, -s75
    v_cvt_pk_bf16_f32 v34, v34, v35
    v_perm_b32 v106, v106, v34, s76
    v_perm_b32 v107, v107, v34, s77
    ds_write_b32 v6, v106 offset:256
    ds_write_b32 v6, v107 offset:384
    ds_read_b128 v[72:75], v7
    v_rcp_f32 v36, v36
    v_mul_f32 v108, s74, v108
    v_rcp_f32 v37, v37
    v_mul_f32 v109, s74, v109
    v_med3_f32 v36, v36, s75, -s75
    v_med3_f32 v37, v37, s75, -s75
    v_cvt_pk_bf16_f32 v36, v36, v37
    v_perm_b32 v108, v108, v36, s76
    v_perm_b32 v109, v109, v36, s77
    ds_write_b32 v6, v108 offset:0
    ds_write_b32 v6, v109 offset:128
    v_rcp_f32 v38, v38
    v_mul_f32 v110, s74, v110
    v_rcp_f32 v39, v39
    v_mul_f32 v111, s74, v111
    v_med3_f32 v38, v38, s75, -s75
    v_med3_f32 v39, v39, s75, -s75
    v_cvt_pk_bf16_f32 v38, v38, v39
    v_perm_b32 v110, v110, v38, s76
    v_perm_b32 v111, v111, v38, s77
    ds_write_b32 v6, v110 offset:256
    ds_write_b32 v6, v111 offset:384
    ds_read_b128 v[76:79], v7
    v_rcp_f32 v40, v40
    v_mul_f32 v112, s74, v112
    v_rcp_f32 v41, v41
    v_mul_f32 v113, s74, v113
    v_med3_f32 v40, v40, s75, -s75
    v_med3_f32 v41, v41, s75, -s75
    v_cvt_pk_bf16_f32 v40, v40, v41
    v_perm_b32 v112, v112, v40, s76
    v_perm_b32 v113, v113, v40, s77
    ds_write_b32 v6, v112 offset:0
    ds_write_b32 v6, v113 offset:128
    v_rcp_f32 v42, v42
    v_mul_f32 v114, s74, v114
    v_rcp_f32 v43, v43
    v_mul_f32 v115, s74, v115
    v_med3_f32 v42, v42, s75, -s75
    v_med3_f32 v43, v43, s75, -s75
    v_cvt_pk_bf16_f32 v42, v42, v43
    v_perm_b32 v114, v114, v42, s76
    v_perm_b32 v115, v115, v42, s77
    ds_write_b32 v6, v114 offset:256
    ds_write_b32 v6, v115 offset:384
    ds_read_b128 v[80:83], v7
    v_rcp_f32 v44, v44
    v_mul_f32 v116, s74, v116
    v_rcp_f32 v45, v45
    v_mul_f32 v117, s74, v117
    v_med3_f32 v44, v44, s75, -s75
    v_med3_f32 v45, v45, s75, -s75
    v_cvt_pk_bf16_f32 v44, v44, v45
    v_perm_b32 v116, v116, v44, s76
    v_perm_b32 v117, v117, v44, s77
    ds_write_b32 v6, v116 offset:0
    ds_write_b32 v6, v117 offset:128
    ds_read_b128 v[84:87], v7
    s_waitcnt lgkmcnt(0)
    buffer_store_dwordx4 v[72:75], v5, s[28:31], 0 offen offset:0 sc1
    buffer_store_dwordx4 v[76:79], v5, s[28:31], 0 offen offset:1024 sc1
    buffer_store_dwordx4 v[80:83], v5, s[28:31], 0 offen offset:2048 sc1
    s_sub_u32 s88, s71, 24
    s_lshl_b32 s88, s88, 3
    s_bfm_b64 exec, s88, 0
    buffer_store_dwordx4 v[84:87], v5, s[28:31], 0 offen offset:3072 sc1
    s_mov_b64 exec, -1
    s_nop 0
    s_setprio 1
    v_mov_b32 v2, 0
    s_mov_b32 s94, 0
    s_cmp_lg_u32 s68, 15
    s_cbranch_scc1 K_poc
    s_cmp_eq_u64 s[44:45], 0
    s_cbranch_scc1 K_poc
K_plc:
    s_waitcnt vmcnt(0)
    v_xor_b32 v51, s99, v48
    v_and_b32 v51, 0xf800f800, v51
    v_xor_b32 v7, s98, v49
    v_or3_b32 v6, v51, v7, 0
    v_xor_b32 v55, s99, v52
    v_and_b32 v55, 0xf800f800, v55
    v_xor_b32 v7, s98, v53
    v_or3_b32 v6, v55, v7, v6
    v_xor_b32 v123, s99, v120
    v_and_b32 v123, 0xf800f800, v123
    v_xor_b32 v7, s98, v121
    v_or3_b32 v6, v123, v7, v6
    v_xor_b32 v127, s99, v124
    v_and_b32 v127, 0xf800f800, v127
    v_xor_b32 v7, s98, v125
    v_or3_b32 v6, v127, v7, v6
    v_cmp_ne_u32 s[44:45], 0, v6
    s_sub_u32 s95, s95, 1
    s_cselect_b64 s[44:45], 0, s[44:45]
    s_cmp_lg_u64 s[44:45], 0
    s_cbranch_scc1 K_pac
    v_lshlrev_b32 v7, 5, v1
    v_add_u32 v7, 62848, v7
    v_mov_b32 v6, s98
    ds_write2_b32 v7, v48, v50 offset0:0 offset1:1
    ds_write2_b32 v7, v52, v54 offset0:2 offset1:3
    ds_write2_b32 v7, v120, v122 offset0:4 offset1:5
    ds_write2_b32 v7, v124, v126 offset0:6 offset1:7
    ds_write_b32 v10, v6 offset:1664
    s_branch K_poc
K_pac:
    s_sleep 8
    s_mov_b64 exec, s[44:45]
    buffer_load_dwordx3 v[48:50], v8, s[40:43], 0 offen offset:0 sc1
    buffer_load_dwordx3 v[52:54], v8, s[40:43], 0 offen offset:2048 sc1
    buffer_load_dwordx3 v[120:122], v9, s[40:43], 0 offen offset:0 sc1
    buffer_load_dwordx3 v[124:126], v9, s[40:43], 0 offen offset:2048 sc1
    s_mov_b64 exec, -1
    s_branch K_plc
K_poc:
    s_cmp_lt_u32 s68, 4
    s_cbranch_scc1 K_pass2
    s_waitcnt vmcnt(0)
    s_call_b64 s[64:65], K_sub_pub
    s_mov_b32 s94, 1
K_pass2:
    s_branch K_wf2
K_wf2_nap:
    s_sleep 3
K_wf2:
    ds_read_b32 v11, v10 offset:1688
    s_waitcnt lgkmcnt(0)
    v_readfirstlane_b32 s88, v11
    s_cmp_lt_u32 s88, 4
    s_cbranch_scc1 K_wf2_nap
    v_lshrrev_b32 v12, 2, v0
    v_lshlrev_b32 v12, 3, v12
    v_add_u32 v12, 62848, v12
    v_mov_b32 v7, 0
    ds_read_b32 v13, v7 offset:1664
    ds_read_b64 v[14:15], v12
    s_waitcnt lgkmcnt(0)
    v_readfirstlane_b32 s98, v13
    s_cmp_eq_u32 s98, 0
    s_cbranch_scc1 K_hlate
    s_call_b64 s[64:65], K_sub_first
K_hlate:
    ds_read_b64_tr_b16 v[88:89], v4 offset:0
    ds_read_b64_tr_b16 v[90:91], v4 offset:512
    ds_read_b64_tr_b16 v[92:93], v4 offset:49152
    ds_read_b64_tr_b16 v[94:95], v4 offset:49664
    ds_read_b64_tr_b16 v[48:49], v4 offset:2048
    ds_read_b64_tr_b16 v[50:51], v4 offset:2560
    ds_read_b64_tr_b16 v[52:53], v4 offset:51200
    ds_read_b64_tr_b16 v[54:55], v4 offset:51712
    s_waitcnt lgkmcnt(4)
    v_mfma_f32_32x32x16_bf16 v[72:87], v[16:19], v[88:91], 0
    v_mfma_f32_32x32x16_bf16 v[32:47], v[92:95], v[16:19], 0
    ds_read_b64_tr_b16 v[88:89], v4 offset:4096
    ds_read_b64_tr_b16 v[90:91], v4 offset:4608
    ds_read_b64_tr_b16 v[92:93], v4 offset:53248
    ds_read_b64_tr_b16 v[94:95], v4 offset:53760
    s_waitcnt lgkmcnt(4)
    v_mfma_f32_32x32x16_bf16 v[72:87], v[20:23], v[48:51], v[72:87]
    v_mfma_f32_32x32x16_bf16 v[32:47], v[52:55], v[20:23], v[32:47]
    ds_read_b64_tr_b16 v[48:49], v4 offset:6144
    ds_read_b64_tr_b16 v[50:51], v4 offset:6656
    ds_read_b64_tr_b16 v[52:53], v4 offset:55296
    ds_read_b64_tr_b16 v[54:55], v4 offset:55808
    s_waitcnt lgkmcnt(4)
    v_mfma_f32_32x32x16_bf16 v[72:87], v[24:27], v[88:91], v[72:87]
    v_mfma_f32_32x32x16_bf16 v[32:47], v[92:95], v[24:27], v[32:47]
    ds_read_b64_tr_b16 v[88:89], v4 offset:8192
    ds_read_b64_tr_b16 v[90:91], v4 offset:8704
    ds_read_b64_tr_b16 v[92:93], v4 offset:57344
    ds_read_b64_tr_b16 v[94:95], v4 offset:57856
    s_waitcnt lgkmcnt(4)
    v_mfma_f32_32x32x16_bf16 v[72:87], v[28:31], v[48:51], v[72:87]
    v_mfma_f32_32x32x16_bf16 v[32:47], v[52:55], v[28:31], v[32:47]
    ds_read_b64_tr_b16 v[48:49], v4 offset:10240
    ds_read_b64_tr_b16 v[50:51], v4 offset:10752
    ds_read_b64_tr_b16 v[52:53], v4 offset:59392
    ds_read_b64_tr_b16 v[54:55], v4 offset:59904
    s_waitcnt lgkmcnt(4)
    v_mfma_f32_32x32x16_bf16 v[72:87], v[56:59], v[88:91], v[72:87]
    v_mfma_f32_32x32x16_bf16 v[32:47], v[92:95], v[56:59], v[32:47]
    ds_read_b64_tr_b16 v[88:89], v4 offset:12288
    ds_read_b64_tr_b16 v[90:91], v4 offset:12800
    ds_read_b64_tr_b16 v[92:93], v4 offset:61440
    ds_read_b64_tr_b16 v[94:95], v4 offset:61952
    s_waitcnt lgkmcnt(4)
    v_mfma_f32_32x32x16_bf16 v[72:87], v[60:63], v[48:51], v[72:87]
    v_mfma_f32_32x32x16_bf16 v[32:47], v[52:55], v[60:63], v[32:47]
    ds_read_b64_tr_b16 v[48:49], v4 offset:14336
    ds_read_b64_tr_b16 v[50:51], v4 offset:14848
    ds_read_b64_tr_b16 v[52:53], v4 offset:63488
    ds_read_b64_tr_b16 v[54:55], v4 offset:64000
    s_waitcnt lgkmcnt(4)
    v_mfma_f32_32x32x16_bf16 v[72:87], v[64:67], v[88:91], v[72:87]
    v_mfma_f32_32x32x16_bf16 v[32:47], v[92:95], v[64:67], v[32:47]
    s_waitcnt lgkmcnt(0)
    v_mfma_f32_32x32x16_bf16 v[72:87], v[68:71], v[48:51], v[72:87]
    v_mfma_f32_32x32x16_bf16 v[32:47], v[52:55], v[68:71], v[32:47]
    v_bfe_u32 v6, v1, 2, 1
    v_lshlrev_b32 v6, 5, v6
    v_bfe_u32 v7, v1, 3, 2
    v_lshl_add_u32 v6, v7, 3, v6
    v_and_b32 v7, 3, v1
    v_lshl_add_u32 v6, v7, 1, v6
    s_and_b32 s88, s68, 1
    s_lshl_b32 s88, s88, 6
    s_add_u32 s88, s88, 162176
    v_add_u32 v6, s88, v6
    ds_read_u16 v88, v6 offset:0
    ds_read_u16 v89, v6 offset:128
    ds_read_u16 v90, v6 offset:256
    ds_read_u16 v91, v6 offset:384
    s_waitcnt lgkmcnt(0)
    v_lshlrev_b32 v88, 16, v88
    v_lshlrev_b32 v89, 16, v89
    v_lshlrev_b32 v90, 16, v90
    v_lshlrev_b32 v91, 16, v91
    v_mul_f32 v88, s74, v88
    v_mul_f32 v89, s74, v89
    v_mul_f32 v90, s74, v90
    v_mul_f32 v91, s74, v91
    v_cvt_pk_bf16_f32 v6, v88, v89
    v_cvt_pk_bf16_f32 v7, v90, v91
    s_nop 3
    v_mul_f32 v72, s74, v72
    v_mul_f32 v73, s74, v73
    v_mul_f32 v74, s74, v74
    v_mul_f32 v75, s74, v75
    v_mul_f32 v76, s74, v76
    v_mul_f32 v77, s74, v77
    v_mul_f32 v78, s74, v78
    v_mul_f32 v79, s74, v79
    v_mul_f32 v80, s74, v80
    v_mul_f32 v81, s74, v81
    v_mul_f32 v82, s74, v82
    v_mul_f32 v83, s74, v83
    v_mul_f32 v84, s74, v84
    v_mul_f32 v85, s74, v85
    v_cvt_pk_bf16_f32 v48, v72, v73
    v_cvt_pk_bf16_f32 v49, v74, v75
    v_cvt_pk_bf16_f32 v50, v76, v77
    v_cvt_pk_bf16_f32 v51, v78, v79
    v_cvt_pk_bf16_f32 v52, v80, v81
    v_cvt_pk_bf16_f32 v53, v82, v83
    v_cvt_pk_bf16_f32 v54, v84, v85
    s_cmp_eq_u32 s73, 25
    s_cselect_b32 s88, 0xffff, 0
    v_and_b32 v54, s88, v54
    v_cndmask_b32 v54, v54, v6, s[86:87]
    v_cndmask_b32 v55, 0, v7, s[86:87]
    s_branch K_xr
K_xr_nap:
    s_sleep 3
K_xr:
    ds_read_b32 v11, v10 offset:1692
    s_waitcnt lgkmcnt(0)
    v_readfirstlane_b32 s88, v11
    s_cmp_lt_u32 s88, 16
    s_cbranch_scc1 K_xr_nap
    s_cmp_lg_u32 s98, 0
    s_cbranch_scc1 K_hgone
K_hwait:
    v_mov_b32 v7, 0
    ds_read_b32 v13, v7 offset:1664
    ds_read_b64 v[14:15], v12
    s_waitcnt lgkmcnt(0)
    v_readfirstlane_b32 s98, v13
    s_cmp_lg_u32 s98, 0
    s_cbranch_scc1 K_hgo
    s_cmp_lg_u32 s94, 0
    s_cbranch_scc1 K_hsleep
    s_waitcnt vmcnt(0)
    s_call_b64 s[64:65], K_sub_pub
    s_mov_b32 s94, 1
K_hsleep:
    s_sleep 1
    s_branch K_hwait
K_hgo:
    s_call_b64 s[64:65], K_sub_first
K_hgone:
    s_cmp_lg_u32 s94, 0
    s_cbranch_scc1 K_pubdone
    s_waitcnt vmcnt(0)
    s_call_b64 s[64:65], K_sub_pub
K_pubdone:
    s_waitcnt vmcnt(0)
    s_mov_b32 s99, 0
    s_cmp_lg_u32 s68, 14
    s_cbranch_scc1 K_tf_noissue
    s_lshr_b32 s88, s70, 1
    s_lshl_b32 s88, s88, 14
    s_add_u32 s88, s88, 524288
    v_lshl_add_u32 v3, v1, 8, s88
    buffer_load_dwordx2 v[16:17], v3, s[40:43], 0 offen sc1
    buffer_load_dwordx2 v[18:19], v3, s[40:43], 0 offen offset:128 sc1
K_tf_noissue:
    s_mov_b64 exec, s[4:5]
    s_cbranch_execz K_csa
    v_add3_u32 v2, v2, v96, v97
    v_add_u32 v2, v2, v98
    s_mov_b64 exec, s[6:7]
    s_cbranch_execz K_csa
    v_add3_u32 v2, v2, v100, v101
    v_add_u32 v2, v2, v102
    s_mov_b64 exec, s[8:9]
    s_cbranch_execz K_csa
    v_add3_u32 v2, v2, v104, v105
    v_add_u32 v2, v2, v106
    s_mov_b64 exec, s[10:11]
    s_cbranch_execz K_csa
    v_add3_u32 v2, v2, v108, v109
    v_add_u32 v2, v2, v110
    s_mov_b64 exec, s[12:13]
    s_cbranch_execz K_csa
    v_add3_u32 v2, v2, v112, v113
    v_add_u32 v2, v2, v114
    s_mov_b64 exec, s[14:15]
    s_cbranch_execz K_csa
    v_add3_u32 v2, v2, v116, v117
    v_add_u32 v2, v2, v118
    s_mov_b64 exec, s[16:17]
    s_cbranch_execz K_csa
    v_add3_u32 v2, v2, v120, v121
    v_add_u32 v2, v2, v122
    s_mov_b64 exec, s[18:19]
    s_cbranch_execz K_csa
    v_add3_u32 v2, v2, v124, v125
    v_add_u32 v2, v2, v126
K_csa:
    s_mov_b64 exec, -1
    v_and_b32 v6, 3, v0
    v_add_u32 v6, v6, v13
    v_cmp_lt_i32 s[96:97], 32, v6
    s_nop 1
    v_add_u32_dpp v2, v2, v2 quad_perm:[1,0,3,2] row_mask:0xf bank_mask:0xf
    s_nop 1
    v_add_u32_dpp v2, v2, v2 quad_perm:[2,3,0,1] row_mask:0xf bank_mask:0xf
    v_cmp_ne_u32 vcc, v2, v15
    s_cmp_lg_u64 vcc, 0
    s_cbranch_scc1 K_vslow
    s_cmp_lg_u64 s[96:97], 0
    s_cbranch_scc1 K_vslow
K_valid:
K_round:
    s_add_u32 s88, s92, s93
    v_and_b32 v6, 3, v0
    v_add_u32 v6, v6, v13
    v_cmp_lt_i32 vcc, s88, v6
    v_mov_b32 v6, 4
    v_mov_b32 v7, 64
    s_mov_b64 exec, vcc
    ds_add_u32 v7, v6 offset:1536
    s_mov_b64 exec, -1
    v_mov_b32 v7, 0x3c
    s_mov_b64 exec, s[4:5]
    s_cbranch_execz K_ap1a
    v_and_b32_sdwa v99, v98, v7 dst_sel:DWORD dst_unused:UNUSED_PAD src0_sel:BYTE_3 src1_sel:DWORD
    ds_add_rtn_u32 v99, v99, v6 offset:1536
    s_mov_b64 exec, s[6:7]
    s_cbranch_execz K_ap1a
    v_and_b32_sdwa v103, v102, v7 dst_sel:DWORD dst_unused:UNUSED_PAD src0_sel:BYTE_3 src1_sel:DWORD
    ds_add_rtn_u32 v103, v103, v6 offset:1536
    s_mov_b64 exec, s[8:9]
    s_cbranch_execz K_ap1a
    v_and_b32_sdwa v107, v106, v7 dst_sel:DWORD dst_unused:UNUSED_PAD src0_sel:BYTE_3 src1_sel:DWORD
    ds_add_rtn_u32 v107, v107, v6 offset:1536
    s_mov_b64 exec, s[10:11]
    s_cbranch_execz K_ap1a
    v_and_b32_sdwa v111, v110, v7 dst_sel:DWORD dst_unused:UNUSED_PAD src0_sel:BYTE_3 src1_sel:DWORD
    ds_add_rtn_u32 v111, v111, v6 offset:1536
    s_mov_b64 exec, s[12:13]
    s_cbranch_execz K_ap1a
    v_and_b32_sdwa v115, v114, v7 dst_sel:DWORD dst_unused:UNUSED_PAD src0_sel:BYTE_3 src1_sel:DWORD
    ds_add_rtn_u32 v115, v115, v6 offset:1536
    s_mov_b64 exec, s[14:15]
    s_cbranch_execz K_ap1a
    v_and_b32_sdwa v119, v118, v7 dst_sel:DWORD dst_unused:UNUSED_PAD src0_sel:BYTE_3 src1_sel:DWORD
    ds_add_rtn_u32 v119, v119, v6 offset:1536
    s_mov_b64 exec, s[16:17]
    s_cbranch_execz K_ap1a
    v_and_b32_sdwa v123, v122, v7 dst_sel:DWORD dst_unused:UNUSED_PAD src0_sel:BYTE_3 src1_sel:DWORD
    ds_add_rtn_u32 v123, v123, v6 offset:1536
    s_mov_b64 exec, s[18:19]
    s_cbranch_execz K_ap1a
    v_and_b32_sdwa v127, v126, v7 dst_sel:DWORD dst_unused:UNUSED_PAD src0_sel:BYTE_3 src1_sel:DWORD
    ds_add_rtn_u32 v127, v127, v6 offset:1536
K_ap1a:
    s_mov_b64 exec, -1
    s_waitcnt lgkmcnt(0)
    s_mov_b64 exec, s[4:5]
    s_cbranch_execz K_ap2
    v_min_u32 v99, s85, v99
    v_lshlrev_b32 v6, 1, v99
    ds_write_b32 v99, v98
    ds_write_b64 v6, v[96:97] offset:18560
    s_mov_b64 exec, s[6:7]
    s_cbranch_execz K_ap2
    v_min_u32 v103, s85, v103
    v_lshlrev_b32 v6, 1, v103
    ds_write_b32 v103, v102
    ds_write_b64 v6, v[100:101] offset:18560
    s_mov_b64 exec, s[8:9]
    s_cbranch_execz K_ap2
    v_min_u32 v107, s85, v107
    v_lshlrev_b32 v6, 1, v107
    ds_write_b32 v107, v106
    ds_write_b64 v6, v[104:105] offset:18560
    s_mov_b64 exec, s[10:11]
    s_cbranch_execz K_ap2
    v_min_u32 v111, s85, v111
    v_lshlrev_b32 v6, 1, v111
    ds_write_b32 v111, v110
    ds_write_b64 v6, v[108:109] offset:18560
    s_mov_b64 exec, s[12:13]
    s_cbranch_execz K_ap2
    v_min_u32 v115, s85, v115
    v_lshlrev_b32 v6, 1, v115
    ds_write_b32 v115, v114
    ds_write_b64 v6, v[112:113] offset:18560
    s_mov_b64 exec, s[14:15]
    s_cbranch_execz K_ap2
    v_min_u32 v119, s85, v119
    v_lshlrev_b32 v6, 1, v119
    ds_write_b32 v119, v118
    ds_write_b64 v6, v[116:117] offset:18560
    s_mov_b64 exec, s[16:17]
    s_cbranch_execz K_ap2
    v_min_u32 v123, s85, v123
    v_lshlrev_b32 v6, 1, v123
    ds_write_b32 v123, v122
    ds_write_b64 v6, v[120:121] offset:18560
    s_mov_b64 exec, s[18:19]
    s_cbranch_execz K_ap2
    v_min_u32 v127, s85, v127
    v_lshlrev_b32 v6, 1, v127
    ds_write_b32 v127, v126
    ds_write_b64 v6, v[124:125] offset:18560
K_ap2:
    s_mov_b64 exec, -1
    s_lshl_b32 s88, s68, 11
    s_add_u32 s88, s88, 62848
    v_lshl_add_u32 v5, v1, 4, s88
    v_mov_b32 v104, 0
    v_mov_b32 v105, 0
    v_mov_b32 v106, 0
    v_mov_b32 v107, 0
    v_mov_b32 v10, 0x3f80
    v_mov_b32 v11, 0
    v_and_b32 v6, 31, v1
    v_mov_b32 v3, 0x3f803f80
    v_lshlrev_b32 v7, 2, v6
    v_cvt_f32_u32 v7, v7
    v_lshrrev_b32 v7, 16, v7
    v_or_b32 v7, 0x4b000000, v7
    v_mov_b32 v14, 0x47004300
    v_cndmask_b32 v14, v14, v11, s[86:87]
    v_cndmask_b32 v15, v7, v11, s[86:87]
    v_lshl_add_u32 v6, v6, 6, s88
    v_bfe_u32 v7, v1, 2, 2
    v_lshl_add_u32 v120, v7, 4, v6
    v_xor_b32 v121, 56, v120
    v_lshrrev_b32 v6, 5, v1
    v_lshlrev_b32 v122, 4, v6
    v_xor_b32 v122, v122, v120
    v_xor_b32 v123, 32, v122
    v_mov_b32 v126, v120
    v_lshl_add_u32 v7, v6, 2, v7
    v_lshl_add_u32 v124, v7, 6, s88
    v_bfe_u32 v7, v1, 4, 1
    v_lshlrev_b32 v7, 1, v7
    v_and_b32 v125, 1, v1
    v_or_b32 v7, v7, v125
    v_xor_b32 v7, v7, v6
    v_lshl_add_u32 v124, v7, 4, v124
    v_and_b32 v7, 2, v1
    v_lshl_add_u32 v124, v7, 2, v124
    v_xor_b32 v125, 32, v124
    v_add_u32 v125, 512, v125
    s_cmp_lg_u32 s68, 14
    s_cbranch_scc1 K_tf_done
    s_cmp_lg_u32 s99, 0
    s_cbranch_scc1 K_tf_done
    s_lshr_b32 s88, s70, 1
    s_lshl_b32 s88, s88, 14
    s_add_u32 s88, s88, 524288
    v_lshl_add_u32 v6, v1, 8, s88
    s_not_b32 s89, s98
    s_mov_b32 s95, 1000000
    s_branch K_tf_first
K_tf_loop:
    buffer_load_dwordx2 v[16:17], v6, s[40:43], 0 offen sc1
    buffer_load_dwordx2 v[18:19], v6, s[40:43], 0 offen offset:128 sc1
K_tf_first:
    s_waitcnt vmcnt(0)
    v_xor_b32 v20, s98, v16
    v_xor_b32 v21, s89, v17
    v_xor_b32 v22, s98, v18
    v_xor_b32 v23, s89, v19
    v_or3_b32 v20, v20, v21, v22
    v_or_b32 v20, v20, v23
    v_cmp_ne_u32 vcc, 0, v20
    s_and_b64 exec, exec, vcc
    s_cbranch_scc0 K_tf_end
    s_sleep 2
    s_sub_u32 s95, s95, 1
    s_cbranch_scc0 K_tf_loop
K_tf_end:
    s_mov_b64 exec, -1
    s_mov_b32 s99, 1
K_tf_done:
    s_lshl_b32 s88, s72, 7
    v_lshl_add_u32 v6, v1, 4, s88
    s_mov_b32 m0, 161152
    s_nop 0
    buffer_load_dwordx4 v6, s[28:31], 0 offen offset:0 lds
    s_mov_b32 m0, 160128
    s_nop 0
    buffer_load_dwordx4 v6, s[28:31], 0 offen offset:1024 lds
    s_mov_b32 m0, 159104
    s_nop 0
    buffer_load_dwordx4 v6, s[28:31], 0 offen offset:2048 lds
    s_waitcnt lgkmcnt(0)
    s_barrier
    ds_write_b128 v5, v[104:107]
    ds_write_b128 v5, v[104:107] offset:1024
    v_and_b32 v6, 31, v1
    v_lshlrev_b32 v4, 2, v6
    ds_read_b32 v7, v4 offset:1536
    v_lshrrev_b32 v6, 1, v1
    v_mul_u32_u24 v6, 2544, v6
    v_and_b32 v8, 1, v1
    v_mul_u32_u24 v8, 1080, v8
    v_add_u32 v6, v6, v8
    v_add_u32 v6, 1792, v6
    v_add_u32 v6, 1080, v6
    s_mul_i32 s88, s3, 2544
    s_add_u32 s88, s88, 1792
    s_and_b32 s94, s68, 14
    s_or_b32 s95, s68, 1
    s_waitcnt lgkmcnt(0)
    v_readlane_b32 s89, v7, s94
    v_readlane_b32 s90, v7, s95
    v_readlane_b32 s91, v7, 16
    v_cmp_lt_u32 vcc, v6, v7
    s_and_b32 s94, vcc_lo, 0xffff
    s_cbranch_scc1 K_overflow
    s_sub_u32 s81, s89, s88
    s_and_b32 s95, s81, 127
    s_sub_u32 s89, s89, s95
    v_lshl_add_u32 v6, v1, 2, s89
    v_lshlrev_b32 v7, 1, v6
    ds_read_b32 v127, v6
    ds_read_b64 v[8:9], v7 offset:18560
    s_lshr_b32 s81, s81, 7
    v_lshlrev_b32 v6, 2, v1
    v_cmp_gt_u32 vcc, s95, v6
    v_add_u32 v6, s90, v6
    v_lshlrev_b32 v7, 1, v6
    v_mov_b32 v56, 0x2e61a8
    s_add_u32 s82, s88, 1080
    s_sub_u32 s94, s90, s82
    s_add_u32 s94, s94, s95
    s_add_u32 s94, s94, 63
    s_lshr_b32 s94, s94, 6
    s_and_b32 s83, s94, 1
    s_lshr_b32 s94, s94, 1
    s_cmp_eq_u32 s81, 0
    s_cselect_b32 s88, s82, s88
    v_add_u32 v4, s88, v4
    v_lshlrev_b32 v5, 1, v4
    s_sub_u32 s82, s82, s89
    s_add_u32 s82, s82, 128
    s_waitcnt lgkmcnt(0)
    v_cndmask_b32 v127, v56, v127, vcc
    v_cndmask_b32 v8, 0, v8, vcc
    v_cndmask_b32 v9, 0, v9, vcc
    ds_write_b32 v6, v127
    ds_write_b64 v7, v[8:9] offset:18560
    s_not_b64 exec, s[86:87]
    ds_write_b32 v6, v56 offset:256
    ds_write_b64 v7, v[104:105] offset:19072
    s_mov_b64 exec, -1
    s_add_u32 s94, s94, s81
    s_or_b32 s88, s94, s83
    s_cbranch_scc0 K_tiles_done
    s_mov_b32 s95, 0
    ds_read_b32 v127, v4
    ds_read_b64 v[8:9], v5 offset:18560
    s_cmp_eq_u32 s81, 1
    s_cselect_b32 s89, s82, 128
    s_lshl_b32 s90, s89, 1
    v_add_u32 v4, s89, v4
    v_add_u32 v5, s90, v5
    s_waitcnt lgkmcnt(0)
    v_cvt_f32_ubyte0 v6, v127
    v_cvt_f32_ubyte1 v7, v127
    v_perm_b32 v2, v7, v6, s77
    ds_write_b16 v126, v11
    v_xor_b32_sdwa v126, v127, v120 dst_sel:DWORD dst_unused:UNUSED_PAD src0_sel:BYTE_2 src1_sel:DWORD
    ds_write_b64 v121, v[8:9]
    ds_write_b16 v126, v10
    v_mfma_f32_32x32x8_bf16 v[16:31], v[2:3], v[14:15], 0
    ds_read_b128 v[56:59], v122
    ds_read_b128 v[60:63], v123
    ds_read_b32 v127, v4
    ds_read_b64 v[8:9], v5 offset:18560
    s_cmp_eq_u32 s81, 2
    s_cselect_b32 s89, s82, 128
    s_lshl_b32 s90, s89, 1
    v_add_u32 v4, s89, v4
    v_add_u32 v5, s90, v5
    s_sub_u32 s81, s81, 3
    s_nop 15
    s_waitcnt lgkmcnt(0)
    v_cvt_f32_ubyte0 v6, v127
    v_cvt_f32_ubyte1 v7, v127
    v_perm_b32 v2, v7, v6, s77
    buffer_load_dword v72, v16, s[32:35], 0 offen
    buffer_load_dword v73, v17, s[32:35], 0 offen
    buffer_load_dword v74, v18, s[32:35], 0 offen
    buffer_load_dword v75, v19, s[32:35], 0 offen
    buffer_load_dword v76, v20, s[32:35], 0 offen
    buffer_load_dword v77, v21, s[32:35], 0 offen
    buffer_load_dword v78, v22, s[32:35], 0 offen
    buffer_load_dword v79, v23, s[32:35], 0 offen
    buffer_load_dword v80, v24, s[32:35], 0 offen
    buffer_load_dword v81, v25, s[32:35], 0 offen
    buffer_load_dword v82, v26, s[32:35], 0 offen
    buffer_load_dword v83, v27, s[32:35], 0 offen
    buffer_load_dword v84, v28, s[32:35], 0 offen
    buffer_load_dword v85, v29, s[32:35], 0 offen
    buffer_load_dword v86, v30, s[32:35], 0 offen
    buffer_load_dword v87, v31, s[32:35], 0 offen
    v_mfma_f32_32x32x8_bf16 v[16:31], v[2:3], v[14:15], 0
    s_nop 15
    s_nop 3
    s_setprio 3
    s_cmp_eq_u32 s94, 0
    s_cbranch_scc1 K_half0
K_tile:
    buffer_load_dword v88, v16, s[32:35], 0 offen
    buffer_load_dword v89, v17, s[32:35], 0 offen
    buffer_load_dword v90, v18, s[32:35], 0 offen
    buffer_load_dword v91, v19, s[32:35], 0 offen
    buffer_load_dword v92, v20, s[32:35], 0 offen
    buffer_load_dword v93, v21, s[32:35], 0 offen
    buffer_load_dword v94, v22, s[32:35], 0 offen
    buffer_load_dword v95, v23, s[32:35], 0 offen
    buffer_load_dword v96, v24, s[32:35], 0 offen
    buffer_load_dword v97, v25, s[32:35], 0 offen
    buffer_load_dword v98, v26, s[32:35], 0 offen
    buffer_load_dword v99, v27, s[32:35], 0 offen
    buffer_load_dword v100, v28, s[32:35], 0 offen
    buffer_load_dword v101, v29, s[32:35], 0 offen
    buffer_load_dword v102, v30, s[32:35], 0 offen
    buffer_load_dword v103, v31, s[32:35], 0 offen
    s_cmp_eq_u32 s81, s95
    s_cselect_b32 s89, s82, 128
    s_lshl_b32 s90, s89, 1
    s_sub_u32 s88, s94, s95
    s_cmp_lg_u32 s88, 1
    s_cbranch_scc1 K_b0_p0
    s_setprio 0
K_b0_p0:
    s_cmp_lg_u32 s88, 3
    s_cbranch_scc1 K_b0_p1
    s_setprio 1
K_b0_p1:
    s_cmp_lg_u32 s88, 6
    s_cbranch_scc1 K_b0_p2
    s_setprio 2
K_b0_p2:
    s_waitcnt vmcnt(16)
    v_mfma_f32_32x32x16_bf16 v[104:119], v[56:59], v[48:51], v[72:87]
    v_mfma_f32_32x32x16_bf16 v[104:119], v[60:63], v[52:55], v[104:119]
    ds_read_b64_tr_b16 v[64:65], v124 offset:0
    ds_read_b64_tr_b16 v[66:67], v125 offset:0
    ds_read_b64_tr_b16 v[68:69], v124 offset:1024
    ds_read_b64_tr_b16 v[70:71], v125 offset:1024
    ds_write_b16 v126, v11
    v_xor_b32_sdwa v126, v127, v120 dst_sel:DWORD dst_unused:UNUSED_PAD src0_sel:BYTE_2 src1_sel:DWORD
    ds_write_b64 v121, v[8:9]
    ds_write_b16 v126, v10
    ds_read_b128 v[56:59], v122
    ds_read_b128 v[60:63], v123
    ds_read_b32 v127, v4
    ds_read_b64 v[8:9], v5 offset:18560
    v_add_u32 v4, s89, v4
    v_add_u32 v5, s90, v5
    v_exp_f32 v104, v104
    v_lshlrev_b32 v72, 16, v72
    v_exp_f32 v105, v105
    v_lshlrev_b32 v73, 16, v73
    v_exp_f32 v106, v106
    v_lshlrev_b32 v74, 16, v74
    v_exp_f32 v107, v107
    v_lshlrev_b32 v75, 16, v75
    v_exp_f32 v108, v108
    v_lshlrev_b32 v76, 16, v76
    v_exp_f32 v109, v109
    v_lshlrev_b32 v77, 16, v77
    v_exp_f32 v110, v110
    v_lshlrev_b32 v78, 16, v78
    v_exp_f32 v111, v111
    v_lshlrev_b32 v79, 16, v79
    v_exp_f32 v112, v112
    v_lshlrev_b32 v80, 16, v80
    v_exp_f32 v113, v113
    v_lshlrev_b32 v81, 16, v81
    v_exp_f32 v114, v114
    v_lshlrev_b32 v82, 16, v82
    v_exp_f32 v115, v115
    v_lshlrev_b32 v83, 16, v83
    v_exp_f32 v116, v116
    v_lshlrev_b32 v84, 16, v84
    v_exp_f32 v117, v117
    v_lshlrev_b32 v85, 16, v85
    v_exp_f32 v118, v118
    v_lshlrev_b32 v86, 16, v86
    v_exp_f32 v119, v119
    v_lshlrev_b32 v87, 16, v87
    s_waitcnt lgkmcnt(0)
    v_cvt_f32_ubyte0 v6, v127
    v_cvt_f32_ubyte1 v7, v127
    v_pk_fma_f32 v[104:105], v[104:105], v[72:73], v[72:73]
    v_perm_b32 v2, v7, v6, s77
    v_pk_fma_f32 v[106:107], v[106:107], v[74:75], v[74:75]
    v_pk_fma_f32 v[108:109], v[108:109], v[76:77], v[76:77]
    v_pk_fma_f32 v[110:111], v[110:111], v[78:79], v[78:79]
    v_pk_fma_f32 v[112:113], v[112:113], v[80:81], v[80:81]
    v_pk_fma_f32 v[114:115], v[114:115], v[82:83], v[82:83]
    v_pk_fma_f32 v[116:117], v[116:117], v[84:85], v[84:85]
    v_pk_fma_f32 v[118:119], v[118:119], v[86:87], v[86:87]
    v_mfma_f32_32x32x8_bf16 v[16:31], v[2:3], v[14:15], 0
    v_rcp_f32 v104, v104
    v_rcp_f32 v105, v105
    v_rcp_f32 v106, v106
    v_rcp_f32 v107, v107
    v_cvt_pk_bf16_f32 v72, v104, v105
    v_rcp_f32 v108, v108
    v_rcp_f32 v109, v109
    v_cvt_pk_bf16_f32 v73, v106, v107
    v_rcp_f32 v110, v110
    v_rcp_f32 v111, v111
    v_cvt_pk_bf16_f32 v74, v108, v109
    v_rcp_f32 v112, v112
    v_rcp_f32 v113, v113
    v_cvt_pk_bf16_f32 v75, v110, v111
    v_rcp_f32 v114, v114
    v_rcp_f32 v115, v115
    v_cvt_pk_bf16_f32 v76, v112, v113
    v_rcp_f32 v116, v116
    v_rcp_f32 v117, v117
    v_cvt_pk_bf16_f32 v77, v114, v115
    v_rcp_f32 v118, v118
    v_rcp_f32 v119, v119
    v_cvt_pk_bf16_f32 v78, v116, v117
    s_add_u32 s95, s95, 1
    v_cvt_pk_bf16_f32 v79, v118, v119
    s_cmp_lt_u32 s95, s94
    v_mfma_f32_32x32x16_bf16 v[32:47], v[72:75], v[64:67], v[32:47]
    v_mfma_f32_32x32x16_bf16 v[32:47], v[76:79], v[68:71], v[32:47]
    s_cbranch_scc0 K_exit1
    buffer_load_dword v72, v16, s[32:35], 0 offen
    buffer_load_dword v73, v17, s[32:35], 0 offen
    buffer_load_dword v74, v18, s[32:35], 0 offen
    buffer_load_dword v75, v19, s[32:35], 0 offen
    buffer_load_dword v76, v20, s[32:35], 0 offen
    buffer_load_dword v77, v21, s[32:35], 0 offen
    buffer_load_dword v78, v22, s[32:35], 0 offen
    buffer_load_dword v79, v23, s[32:35], 0 offen
    buffer_load_dword v80, v24, s[32:35], 0 offen
    buffer_load_dword v81, v25, s[32:35], 0 offen
    buffer_load_dword v82, v26, s[32:35], 0 offen
    buffer_load_dword v83, v27, s[32:35], 0 offen
    buffer_load_dword v84, v28, s[32:35], 0 offen
    buffer_load_dword v85, v29, s[32:35], 0 offen
    buffer_load_dword v86, v30, s[32:35], 0 offen
    buffer_load_dword v87, v31, s[32:35], 0 offen
    s_cmp_eq_u32 s81, s95
    s_cselect_b32 s89, s82, 128
    s_lshl_b32 s90, s89, 1
    s_sub_u32 s88, s94, s95
    s_cmp_lg_u32 s88, 1
    s_cbranch_scc1 K_b1_p0
    s_setprio 0
K_b1_p0:
    s_cmp_lg_u32 s88, 3
    s_cbranch_scc1 K_b1_p1
    s_setprio 1
K_b1_p1:
    s_cmp_lg_u32 s88, 6
    s_cbranch_scc1 K_b1_p2
    s_setprio 2
K_b1_p2:
    s_waitcnt vmcnt(16)
    v_mfma_f32_32x32x16_bf16 v[104:119], v[56:59], v[48:51], v[88:103]
    v_mfma_f32_32x32x16_bf16 v[104:119], v[60:63], v[52:55], v[104:119]
    ds_read_b64_tr_b16 v[64:65], v124 offset:0
    ds_read_b64_tr_b16 v[66:67], v125 offset:0
    ds_read_b64_tr_b16 v[68:69], v124 offset:1024
    ds_read_b64_tr_b16 v[70:71], v125 offset:1024
    ds_write_b16 v126, v11
    v_xor_b32_sdwa v126, v127, v120 dst_sel:DWORD dst_unused:UNUSED_PAD src0_sel:BYTE_2 src1_sel:DWORD
    ds_write_b64 v121, v[8:9]
    ds_write_b16 v126, v10
    ds_read_b128 v[56:59], v122
    ds_read_b128 v[60:63], v123
    ds_read_b32 v127, v4
    ds_read_b64 v[8:9], v5 offset:18560
    v_add_u32 v4, s89, v4
    v_add_u32 v5, s90, v5
    v_exp_f32 v104, v104
    v_lshlrev_b32 v88, 16, v88
    v_exp_f32 v105, v105
    v_lshlrev_b32 v89, 16, v89
    v_exp_f32 v106, v106
    v_lshlrev_b32 v90, 16, v90
    v_exp_f32 v107, v107
    v_lshlrev_b32 v91, 16, v91
    v_exp_f32 v108, v108
    v_lshlrev_b32 v92, 16, v92
    v_exp_f32 v109, v109
    v_lshlrev_b32 v93, 16, v93
    v_exp_f32 v110, v110
    v_lshlrev_b32 v94, 16, v94
    v_exp_f32 v111, v111
    v_lshlrev_b32 v95, 16, v95
    v_exp_f32 v112, v112
    v_lshlrev_b32 v96, 16, v96
    v_exp_f32 v113, v113
    v_lshlrev_b32 v97, 16, v97
    v_exp_f32 v114, v114
    v_lshlrev_b32 v98, 16, v98
    v_exp_f32 v115, v115
    v_lshlrev_b32 v99, 16, v99
    v_exp_f32 v116, v116
    v_lshlrev_b32 v100, 16, v100
    v_exp_f32 v117, v117
    v_lshlrev_b32 v101, 16, v101
    v_exp_f32 v118, v118
    v_lshlrev_b32 v102, 16, v102
    v_exp_f32 v119, v119
    v_lshlrev_b32 v103, 16, v103
    s_waitcnt lgkmcnt(0)
    v_cvt_f32_ubyte0 v6, v127
    v_cvt_f32_ubyte1 v7, v127
    v_pk_fma_f32 v[104:105], v[104:105], v[88:89], v[88:89]
    v_perm_b32 v2, v7, v6, s77
    v_pk_fma_f32 v[106:107], v[106:107], v[90:91], v[90:91]
    v_pk_fma_f32 v[108:109], v[108:109], v[92:93], v[92:93]
    v_pk_fma_f32 v[110:111], v[110:111], v[94:95], v[94:95]
    v_pk_fma_f32 v[112:113], v[112:113], v[96:97], v[96:97]
    v_pk_fma_f32 v[114:115], v[114:115], v[98:99], v[98:99]
    v_pk_fma_f32 v[116:117], v[116:117], v[100:101], v[100:101]
    v_pk_fma_f32 v[118:119], v[118:119], v[102:103], v[102:103]
    v_mfma_f32_32x32x8_bf16 v[16:31], v[2:3], v[14:15], 0
    v_rcp_f32 v104, v104
    v_rcp_f32 v105, v105
    v_rcp_f32 v106, v106
    v_rcp_f32 v107, v107
    v_cvt_pk_bf16_f32 v88, v104, v105
    v_rcp_f32 v108, v108
    v_rcp_f32 v109, v109
    v_cvt_pk_bf16_f32 v89, v106, v107
    v_rcp_f32 v110, v110
    v_rcp_f32 v111, v111
    v_cvt_pk_bf16_f32 v90, v108, v109
    v_rcp_f32 v112, v112
    v_rcp_f32 v113, v113
    v_cvt_pk_bf16_f32 v91, v110, v111
    v_rcp_f32 v114, v114
    v_rcp_f32 v115, v115
    v_cvt_pk_bf16_f32 v92, v112, v113
    v_rcp_f32 v116, v116
    v_rcp_f32 v117, v117
    v_cvt_pk_bf16_f32 v93, v114, v115
    v_rcp_f32 v118, v118
    v_rcp_f32 v119, v119
    v_cvt_pk_bf16_f32 v94, v116, v117
    s_add_u32 s95, s95, 1
    v_cvt_pk_bf16_f32 v95, v118, v119
    s_cmp_lt_u32 s95, s94
    v_mfma_f32_32x32x16_bf16 v[32:47], v[88:91], v[64:67], v[32:47]
    v_mfma_f32_32x32x16_bf16 v[32:47], v[92:95], v[68:71], v[32:47]
    s_cbranch_scc1 K_tile
    s_cmp_eq_u32 s83, 0
    s_cbranch_scc1 K_tiles_done
K_half0:
    s_waitcnt vmcnt(0)
    v_mfma_f32_32x32x16_bf16 v[104:119], v[56:59], v[48:51], v[72:87]
    v_mfma_f32_32x32x16_bf16 v[104:119], v[60:63], v[52:55], v[104:119]
    ds_read_b64_tr_b16 v[64:65], v124
    ds_read_b64_tr_b16 v[66:67], v125
    s_nop 9
    v_exp_f32 v104, v104
    v_lshlrev_b32 v72, 16, v72
    v_exp_f32 v105, v105
    v_lshlrev_b32 v73, 16, v73
    v_exp_f32 v106, v106
    v_lshlrev_b32 v74, 16, v74
    v_exp_f32 v107, v107
    v_lshlrev_b32 v75, 16, v75
    v_exp_f32 v108, v108
    v_lshlrev_b32 v76, 16, v76
    v_exp_f32 v109, v109
    v_lshlrev_b32 v77, 16, v77
    v_exp_f32 v110, v110
    v_lshlrev_b32 v78, 16, v78
    v_exp_f32 v111, v111
    v_lshlrev_b32 v79, 16, v79
    v_pk_fma_f32 v[104:105], v[104:105], v[72:73], v[72:73]
    v_pk_fma_f32 v[106:107], v[106:107], v[74:75], v[74:75]
    v_pk_fma_f32 v[108:109], v[108:109], v[76:77], v[76:77]
    v_pk_fma_f32 v[110:111], v[110:111], v[78:79], v[78:79]
    v_rcp_f32 v104, v104
    v_rcp_f32 v105, v105
    v_rcp_f32 v106, v106
    v_rcp_f32 v107, v107
    v_rcp_f32 v108, v108
    v_rcp_f32 v109, v109
    v_rcp_f32 v110, v110
    v_rcp_f32 v111, v111
    v_cvt_pk_bf16_f32 v72, v104, v105
    v_cvt_pk_bf16_f32 v73, v106, v107
    v_cvt_pk_bf16_f32 v74, v108, v109
    v_cvt_pk_bf16_f32 v75, v110, v111
    s_waitcnt lgkmcnt(0)
    s_nop 0
    v_mfma_f32_32x32x16_bf16 v[32:47], v[72:75], v[64:67], v[32:47]
    s_branch K_tiles_done
K_exit1:
    s_cmp_eq_u32 s83, 0
    s_cbranch_scc1 K_tiles_done
    s_waitcnt vmcnt(0)
    v_mfma_f32_32x32x16_bf16 v[104:119], v[56:59], v[48:51], v[88:103]
    v_mfma_f32_32x32x16_bf16 v[104:119], v[60:63], v[52:55], v[104:119]
    ds_read_b64_tr_b16 v[64:65], v124
    ds_read_b64_tr_b16 v[66:67], v125
    s_nop 9
    v_exp_f32 v104, v104
    v_lshlrev_b32 v88, 16, v88
    v_exp_f32 v105, v105
    v_lshlrev_b32 v89, 16, v89
    v_exp_f32 v106, v106
    v_lshlrev_b32 v90, 16, v90
    v_exp_f32 v107, v107
    v_lshlrev_b32 v91, 16, v91
    v_exp_f32 v108, v108
    v_lshlrev_b32 v92, 16, v92
    v_exp_f32 v109, v109
    v_lshlrev_b32 v93, 16, v93
    v_exp_f32 v110, v110
    v_lshlrev_b32 v94, 16, v94
    v_exp_f32 v111, v111
    v_lshlrev_b32 v95, 16, v95
    v_pk_fma_f32 v[104:105], v[104:105], v[88:89], v[88:89]
    v_pk_fma_f32 v[106:107], v[106:107], v[90:91], v[90:91]
    v_pk_fma_f32 v[108:109], v[108:109], v[92:93], v[92:93]
    v_pk_fma_f32 v[110:111], v[110:111], v[94:95], v[94:95]
    v_rcp_f32 v104, v104
    v_rcp_f32 v105, v105
    v_rcp_f32 v106, v106
    v_rcp_f32 v107, v107
    v_rcp_f32 v108, v108
    v_rcp_f32 v109, v109
    v_rcp_f32 v110, v110
    v_rcp_f32 v111, v111
    v_cvt_pk_bf16_f32 v88, v104, v105
    v_cvt_pk_bf16_f32 v89, v106, v107
    v_cvt_pk_bf16_f32 v90, v108, v109
    v_cvt_pk_bf16_f32 v91, v110, v111
    s_waitcnt lgkmcnt(0)
    s_nop 0
    v_mfma_f32_32x32x16_bf16 v[32:47], v[88:91], v[64:67], v[32:47]
K_tiles_done:
    s_cmp_eq_u32 s91, 0
    s_cbranch_scc1 K_epi
    s_add_u32 s92, s92, s93
    s_branch K_next
K_overflow:
    s_mov_b32 s93, 1
K_next:
    s_waitcnt vmcnt(0) lgkmcnt(0)
    s_barrier
    s_cmp_lg_u32 s68, 0
    s_cbranch_scc1 K_icr
    v_lshlrev_b32 v7, 2, v1
    v_lshrrev_b32 v8, 1, v1
    v_mul_u32_u24 v8, 2544, v8
    v_and_b32 v9, 1, v1
    v_mul_u32_u24 v9, 1080, v9
    v_add_u32 v8, v8, v9
    v_add_u32 v8, 1792, v8
    v_cmp_gt_u32 vcc, 16, v1
    s_nop 1
    v_cndmask_b32 v8, 0, v8, vcc
    s_not_b64 exec, s[86:87]
    ds_write_b32 v7, v8 offset:1536
    s_mov_b64 exec, -1
K_icr:
    v_subrev_u32 v7, s92, v13
    v_and_b32 v6, 3, v0
    v_sub_u32 v6, s93, v6
    v_min_i32 v7, v7, v6
    s_mul_i32 s88, s92, 12
    v_add_u32 v6, s88, v12
    v_cmp_lt_i32 s[4:5], 0, v7
    v_cmp_lt_i32 s[6:7], 4, v7
    v_cmp_lt_i32 s[8:9], 8, v7
    v_cmp_lt_i32 s[10:11], 12, v7
    v_cmp_lt_i32 s[12:13], 16, v7
    v_cmp_lt_i32 s[14:15], 20, v7
    v_cmp_lt_i32 s[16:17], 24, v7
    v_cmp_lt_i32 s[18:19], 28, v7
    s_mov_b64 exec, s[4:5]
    s_cbranch_execz K_rl_doner
    buffer_load_dwordx3 v[96:98], v6, s[36:39], 0 offen offset:0 sc1
    s_mov_b64 exec, s[6:7]
    s_cbranch_execz K_rl_doner
    buffer_load_dwordx3 v[100:102], v6, s[36:39], 0 offen offset:48 sc1
    s_mov_b64 exec, s[8:9]
    s_cbranch_execz K_rl_doner
    buffer_load_dwordx3 v[104:106], v6, s[36:39], 0 offen offset:96 sc1
    s_mov_b64 exec, s[10:11]
    s_cbranch_execz K_rl_doner
    buffer_load_dwordx3 v[108:110], v6, s[36:39], 0 offen offset:144 sc1
    s_mov_b64 exec, s[12:13]
    s_cbranch_execz K_rl_doner
    buffer_load_dwordx3 v[112:114], v6, s[36:39], 0 offen offset:192 sc1
    s_mov_b64 exec, s[14:15]
    s_cbranch_execz K_rl_doner
    buffer_load_dwordx3 v[116:118], v6, s[36:39], 0 offen offset:240 sc1
    s_mov_b64 exec, s[16:17]
    s_cbranch_execz K_rl_doner
    buffer_load_dwordx3 v[120:122], v6, s[36:39], 0 offen offset:288 sc1
    s_mov_b64 exec, s[18:19]
    s_cbranch_execz K_rl_doner
    buffer_load_dwordx3 v[124:126], v6, s[36:39], 0 offen offset:336 sc1
K_rl_doner:
    s_mov_b64 exec, -1
    s_waitcnt vmcnt(0) lgkmcnt(0)
    s_barrier
    s_branch K_round
K_epi:
    v_and_b32 v6, 31, v1
    v_cmp_gt_u32 vcc, s73, v6
    v_add_u32 v6, s72, v6
    v_lshlrev_b32 v6, 8, v6
    v_lshrrev_b32 v7, 5, v1
    v_lshl_add_u32 v6, v7, 5, v6
    s_lshl_b32 s88, s70, 6
    v_add_u32 v6, s88, v6
    s_nop 7
    v_mul_f32 v104, s74, v32
    v_mul_f32 v105, s74, v33
    v_mul_f32 v106, s74, v34
    v_mul_f32 v107, s74, v35
    v_mul_f32 v108, s74, v36
    v_mul_f32 v109, s74, v37
    v_mul_f32 v110, s74, v38
    v_mul_f32 v111, s74, v39
    v_mul_f32 v112, s74, v40
    v_mul_f32 v113, s74, v41
    v_mul_f32 v114, s74, v42
    v_mul_f32 v115, s74, v43
    v_mul_f32 v116, s74, v44
    v_mul_f32 v117, s74, v45
    v_mul_f32 v118, s74, v46
    v_mul_f32 v119, s74, v47
    v_exp_f32 v104, v104
    v_exp_f32 v105, v105
    v_exp_f32 v106, v106
    v_exp_f32 v107, v107
    v_exp_f32 v108, v108
    v_exp_f32 v109, v109
    v_exp_f32 v110, v110
    v_exp_f32 v111, v111
    v_exp_f32 v112, v112
    v_exp_f32 v113, v113
    v_exp_f32 v114, v114
    v_exp_f32 v115, v115
    v_exp_f32 v116, v116
    v_exp_f32 v117, v117
    v_exp_f32 v118, v118
    v_exp_f32 v119, v119
    v_add_f32 v104, 1.0, v104
    v_add_f32 v105, 1.0, v105
    v_add_f32 v106, 1.0, v106
    v_add_f32 v107, 1.0, v107
    v_add_f32 v108, 1.0, v108
    v_add_f32 v109, 1.0, v109
    v_add_f32 v110, 1.0, v110
    v_add_f32 v111, 1.0, v111
    v_add_f32 v112, 1.0, v112
    v_add_f32 v113, 1.0, v113
    v_add_f32 v114, 1.0, v114
    v_add_f32 v115, 1.0, v115
    v_add_f32 v116, 1.0, v116
    v_add_f32 v117, 1.0, v117
    v_add_f32 v118, 1.0, v118
    v_add_f32 v119, 1.0, v119
    v_rcp_f32 v104, v104
    v_rcp_f32 v105, v105
    v_rcp_f32 v106, v106
    v_rcp_f32 v107, v107
    v_rcp_f32 v108, v108
    v_rcp_f32 v109, v109
    v_rcp_f32 v110, v110
    v_rcp_f32 v111, v111
    v_rcp_f32 v112, v112
    v_rcp_f32 v113, v113
    v_rcp_f32 v114, v114
    v_rcp_f32 v115, v115
    v_rcp_f32 v116, v116
    v_rcp_f32 v117, v117
    v_rcp_f32 v118, v118
    v_rcp_f32 v119, v119
    v_mul_f32 v104, v104, v32
    v_mul_f32 v105, v105, v33
    v_mul_f32 v106, v106, v34
    v_mul_f32 v107, v107, v35
    v_mul_f32 v108, v108, v36
    v_mul_f32 v109, v109, v37
    v_mul_f32 v110, v110, v38
    v_mul_f32 v111, v111, v39
    v_mul_f32 v112, v112, v40
    v_mul_f32 v113, v113, v41
    v_mul_f32 v114, v114, v42
    v_mul_f32 v115, v115, v43
    v_mul_f32 v116, v116, v44
    v_mul_f32 v117, v117, v45
    v_mul_f32 v118, v118, v46
    v_mul_f32 v119, v119, v47
    v_cvt_pk_bf16_f32 v56, v104, v105
    v_cvt_pk_bf16_f32 v57, v106, v107
    v_cvt_pk_bf16_f32 v58, v108, v109
    v_cvt_pk_bf16_f32 v59, v110, v111
    v_cvt_pk_bf16_f32 v60, v112, v113
    v_cvt_pk_bf16_f32 v61, v114, v115
    v_cvt_pk_bf16_f32 v62, v116, v117
    v_cvt_pk_bf16_f32 v63, v118, v119
    s_mov_b64 exec, vcc
    buffer_store_dwordx4 v[56:59], v6, s[24:27], 0 offen nt
    buffer_store_dwordx4 v[60:63], v6, s[24:27], 0 offen offset:16 nt
K_end:
    s_endpgm
K_sub_pub:
    v_mov_b32 v6, 1
    s_mov_b64 exec, 1
    ds_add_rtn_u32 v6, v2, v6 offset:1668
    ds_read_b32 v7, v2 offset:1672
    s_waitcnt lgkmcnt(0)
    v_readfirstlane_b32 s88, v6
    v_readfirstlane_b32 s90, v7
    s_cmp_lg_u32 s88, 15
    s_cbranch_scc1 K_nopub
    s_lshr_b32 s88, s70, 1
    s_lshl_b32 s88, s88, 7
    s_add_u32 s88, s88, s69
    s_lshl_b32 s88, s88, 7
    s_add_u32 s88, s88, 524288
    s_not_b32 s89, s90
    v_mov_b32 v6, s88
    v_mov_b32 v8, s90
    v_mov_b32 v9, s89
    buffer_store_dwordx2 v[8:9], v6, s[40:43], 0 offen sc1
K_nopub:
    s_mov_b64 exec, -1
    s_setpc_b64 s[64:65]
K_sub_first:
    v_and_b32 v6, 3, v0
    v_and_b32 v7, 0x7ff, v14
    v_add_u32 v7, v7, v6
    v_mul_u32_u24 v7, 12, v7
    v_lshrrev_b32 v12, 2, v0
    v_mul_u32_u24 v12, 19200, v12
    v_add_u32 v12, v12, v7
    v_bfe_u32 v13, v14, 16, 11
    v_sub_u32 v13, v13, v6
    s_mov_b32 s92, 0
    s_mov_b32 s93, 32
    v_subrev_u32 v7, s92, v13
    v_and_b32 v6, 3, v0
    v_sub_u32 v6, s93, v6
    v_min_i32 v7, v7, v6
    s_mul_i32 s88, s92, 12
    v_add_u32 v6, s88, v12
    v_cmp_lt_i32 s[4:5], 0, v7
    v_cmp_lt_i32 s[6:7], 4, v7
    v_cmp_lt_i32 s[8:9], 8, v7
    v_cmp_lt_i32 s[10:11], 12, v7
    v_cmp_lt_i32 s[12:13], 16, v7
    v_cmp_lt_i32 s[14:15], 20, v7
    v_cmp_lt_i32 s[16:17], 24, v7
    v_cmp_lt_i32 s[18:19], 28, v7
    s_mov_b64 exec, s[4:5]
    buffer_load_dwordx3 v[96:98], v6, s[36:39], 0 offen offset:0
    s_mov_b64 exec, s[6:7]
    buffer_load_dwordx3 v[100:102], v6, s[36:39], 0 offen offset:48
    s_mov_b64 exec, s[8:9]
    buffer_load_dwordx3 v[104:106], v6, s[36:39], 0 offen offset:96
    s_mov_b64 exec, s[10:11]
    buffer_load_dwordx3 v[108:110], v6, s[36:39], 0 offen offset:144
    s_mov_b64 exec, s[12:13]
    buffer_load_dwordx3 v[112:114], v6, s[36:39], 0 offen offset:192
    s_mov_b64 exec, s[14:15]
    buffer_load_dwordx3 v[116:118], v6, s[36:39], 0 offen offset:240
    s_mov_b64 exec, s[16:17]
    buffer_load_dwordx3 v[120:122], v6, s[36:39], 0 offen offset:288
    s_mov_b64 exec, s[18:19]
    buffer_load_dwordx3 v[124:126], v6, s[36:39], 0 offen offset:336
K_rl_donef:
    s_mov_b64 exec, -1
    s_setpc_b64 s[64:65]
K_sub_loads:
    v_subrev_u32 v7, s92, v13
    v_and_b32 v6, 3, v0
    v_sub_u32 v6, s93, v6
    v_min_i32 v7, v7, v6
    s_mul_i32 s88, s92, 12
    v_add_u32 v6, s88, v12
    v_cmp_lt_i32 s[4:5], 0, v7
    v_cmp_lt_i32 s[6:7], 4, v7
    v_cmp_lt_i32 s[8:9], 8, v7
    v_cmp_lt_i32 s[10:11], 12, v7
    v_cmp_lt_i32 s[12:13], 16, v7
    v_cmp_lt_i32 s[14:15], 20, v7
    v_cmp_lt_i32 s[16:17], 24, v7
    v_cmp_lt_i32 s[18:19], 28, v7
    s_mov_b64 exec, s[4:5]
    s_cbranch_execz K_rl_dones
    buffer_load_dwordx3 v[96:98], v6, s[36:39], 0 offen offset:0 sc1
    s_mov_b64 exec, s[6:7]
    s_cbranch_execz K_rl_dones
    buffer_load_dwordx3 v[100:102], v6, s[36:39], 0 offen offset:48 sc1
    s_mov_b64 exec, s[8:9]
    s_cbranch_execz K_rl_dones
    buffer_load_dwordx3 v[104:106], v6, s[36:39], 0 offen offset:96 sc1
    s_mov_b64 exec, s[10:11]
    s_cbranch_execz K_rl_dones
    buffer_load_dwordx3 v[108:110], v6, s[36:39], 0 offen offset:144 sc1
    s_mov_b64 exec, s[12:13]
    s_cbranch_execz K_rl_dones
    buffer_load_dwordx3 v[112:114], v6, s[36:39], 0 offen offset:192 sc1
    s_mov_b64 exec, s[14:15]
    s_cbranch_execz K_rl_dones
    buffer_load_dwordx3 v[116:118], v6, s[36:39], 0 offen offset:240 sc1
    s_mov_b64 exec, s[16:17]
    s_cbranch_execz K_rl_dones
    buffer_load_dwordx3 v[120:122], v6, s[36:39], 0 offen offset:288 sc1
    s_mov_b64 exec, s[18:19]
    s_cbranch_execz K_rl_dones
    buffer_load_dwordx3 v[124:126], v6, s[36:39], 0 offen offset:336 sc1
K_rl_dones:
    s_mov_b64 exec, -1
    s_setpc_b64 s[64:65]
K_vslow:
    s_mov_b32 s95, 1000000
K_vs_retry:
    s_mov_b32 s92, 0
    v_mov_b32 v2, 0
K_vs_part:
    s_call_b64 s[64:65], K_sub_loads
    s_waitcnt vmcnt(0)
    s_mov_b64 exec, s[4:5]
    s_cbranch_execz K_csv
    v_add3_u32 v2, v2, v96, v97
    v_add_u32 v2, v2, v98
    s_mov_b64 exec, s[6:7]
    s_cbranch_execz K_csv
    v_add3_u32 v2, v2, v100, v101
    v_add_u32 v2, v2, v102
    s_mov_b64 exec, s[8:9]
    s_cbranch_execz K_csv
    v_add3_u32 v2, v2, v104, v105
    v_add_u32 v2, v2, v106
    s_mov_b64 exec, s[10:11]
    s_cbranch_execz K_csv
    v_add3_u32 v2, v2, v108, v109
    v_add_u32 v2, v2, v110
    s_mov_b64 exec, s[12:13]
    s_cbranch_execz K_csv
    v_add3_u32 v2, v2, v112, v113
    v_add_u32 v2, v2, v114
    s_mov_b64 exec, s[14:15]
    s_cbranch_execz K_csv
    v_add3_u32 v2, v2, v116, v117
    v_add_u32 v2, v2, v118
    s_mov_b64 exec, s[16:17]
    s_cbranch_execz K_csv
    v_add3_u32 v2, v2, v120, v121
    v_add_u32 v2, v2, v122
    s_mov_b64 exec, s[18:19]
    s_cbranch_execz K_csv
    v_add3_u32 v2, v2, v124, v125
    v_add_u32 v2, v2, v126
K_csv:
    s_mov_b64 exec, -1
    s_add_u32 s92, s92, 32
    v_and_b32 v6, 3, v0
    v_add_u32 v6, v6, v13
    v_cmp_lt_i32 vcc, s92, v6
    s_cmp_lg_u64 vcc, 0
    s_cbranch_scc1 K_vs_part
    s_nop 1
    v_add_u32_dpp v2, v2, v2 quad_perm:[1,0,3,2] row_mask:0xf bank_mask:0xf
    s_nop 1
    v_add_u32_dpp v2, v2, v2 quad_perm:[2,3,0,1] row_mask:0xf bank_mask:0xf
    v_cmp_ne_u32 vcc, v2, v15
    s_cmp_lg_u64 vcc, 0
    s_cbranch_scc0 K_vs_ok
    s_sub_u32 s95, s95, 1
    s_cbranch_scc0 K_vs_retry
K_vs_ok:
    s_mov_b32 s92, 0
    s_call_b64 s[64:65], K_sub_loads
    s_waitcnt vmcnt(0)
    s_branch K_valid
K_code_end:
.section .rodata,"a"
.p2align 6
.amdhsa_kernel gather_scatter__edge_featured_mpnn_egc__graph_kernel
  .amdhsa_next_free_vgpr 128
  .amdhsa_next_free_sgpr 102
  .amdhsa_accum_offset 128
  .amdhsa_group_segment_fixed_size 0
  .amdhsa_kernarg_size 80
  .amdhsa_user_sgpr_count 2
  .amdhsa_user_sgpr_kernarg_segment_ptr 1
  .amdhsa_system_sgpr_workgroup_id_x 1
.end_amdhsa_kernel
```
